```python
import torch

def _softmax(x, axis=-1):
    return torch.softmax(x, dim=axis)
def _gelu(x):
    return torch.nn.functional.gelu(x, approximate="tanh")
def _silu(x):
    return torch.nn.functional.silu(x)
def _sigmoid(x):
    return torch.sigmoid(x)
def _layernorm(x, axis=-1, eps=1e-5):
    m = x.mean(dim=axis, keepdim=True)
    v = x.var(dim=axis, keepdim=True, unbiased=False)
    return (x - m) / torch.sqrt(v + eps)
def _scatter_add(tgt, idx, src, axis=0):
    return tgt.clone().index_add_(axis, idx, src)
def _segment_sum(src, seg, n):
    out = torch.zeros((n,) + src.shape[1:], dtype=src.dtype)
    return out.index_add_(0, seg, src)
def _pad(x, pw):
    flat = tuple(v for pair in reversed(pw) for v in pair)
    return torch.nn.functional.pad(x, flat)

kernel_name = 'recurrent_scan__compressed_kv_cla__geglu_ffn__decode'

def setup_inputs():

    _w = (lambda a: (lambda t: t.to(torch.bfloat16) if t.is_floating_point() else t)(torch.as_tensor(a)))
    def _A_setup():
        B, H, Sq, Sk, D, M = 2, 32, 1, 8192, 128, 640
        Dc = 4 * D
        return {
            "x": _w((lambda *s: torch.randn(*s, dtype=torch.bfloat16) * 0.05)(B, Sq, M)),
            "c_kv": _w((lambda *s: torch.randn(*s, dtype=torch.bfloat16) * 0.8)(B, Sk, Dc)),
            "w_q": _w((lambda *s: torch.randn(*s, dtype=torch.bfloat16) * 1.6)(M, H, D) * (M ** -0.5)),
            "w_uk": _w((lambda *s: torch.randn(*s, dtype=torch.bfloat16) * 1.6)(Dc, H, D) * (Dc ** -0.5)),
            "w_uv": _w((lambda *s: torch.randn(*s, dtype=torch.bfloat16) * 0.8)(Dc, H, D) * (Dc ** -0.5)),
            "w_o": _w((lambda *s: torch.randn(*s, dtype=torch.bfloat16) * 0.8)(H, D, M) * ((H * D) ** -0.5)),
        }
    _A_in = _A_setup()

    def _B_setup():
        B, S, D, F = 2, 1, 640, 1728
        return {
            "x": _w((lambda *s: torch.randn(*s, dtype=torch.bfloat16) * 0.05)(B, S, D)),
            "w_gate": _w((lambda *s: torch.randn(*s, dtype=torch.bfloat16) * 0.2)(D, F)),
            "w_up": _w((lambda *s: torch.randn(*s, dtype=torch.bfloat16) * 0.2)(D, F)),
            "w_down": _w((lambda *s: torch.randn(*s, dtype=torch.bfloat16) * 0.2)(F, D)),
        }
    _B_in = _B_setup()

    return {
        "A_x": _A_in["x"],
        "A_c_kv": _A_in["c_kv"],
        "A_w_q": _A_in["w_q"],
        "A_w_uk": _A_in["w_uk"],
        "A_w_uv": _A_in["w_uv"],
        "A_w_o": _A_in["w_o"],
        "B_x": _B_in["x"],
        "B_w_gate": _B_in["w_gate"],
        "B_w_up": _B_in["w_up"],
        "B_w_down": _B_in["w_down"],
    }

def reference(A_x, A_c_kv, A_w_q, A_w_uk, A_w_uv, A_w_o, B_x, B_w_gate, B_w_up, B_w_down):
    def _A_ref(x, c_kv, w_q, w_uk, w_uv, w_o):
        B, Sq, M = x.shape[0], x.shape[1], x.shape[2]
        Sk = c_kv.shape[1]
        H, D = w_q.shape[1], w_q.shape[2]
        q = torch.einsum("bqm,mhd->bhqd", x, w_q)
        k = torch.einsum("bkc,chd->bhkd", c_kv, w_uk)
        v = torch.einsum("bkc,chd->bhkd", c_kv, w_uv)
        scores = torch.einsum("bhqd,bhkd->bhqk", q, k) * (D ** -0.5)
        off = Sk - Sq
        qi = torch.arange(Sq)[:, None]
        kj = torch.arange(Sk)[None, :]
        cmask = kj <= (qi + off)
        scores = torch.where(cmask[None, None], scores, -1e9)
        p = _softmax(scores, axis=-1)
        ctx = torch.einsum("bhqk,bhkd->bhqd", p, v)
        return torch.einsum("bhqd,hdm->bqm", ctx, w_o)

    def _B_ref(x, w_gate, w_up, w_down):
        return (_gelu(x @ w_gate) * (x @ w_up)) @ w_down

    x = A_x
    xn = _layernorm(x, axis=-1)
    s = _A_ref(xn, A_c_kv, A_w_q, A_w_uk, A_w_uv, A_w_o)
    g = _silu(_B_ref(xn, B_w_gate, B_w_up, B_w_down))
    return x + s * g
```

```asm
; @launch grid=(256,1,1) block=(256,1,1) lds=163840
.amdgcn_target "amdgcn-amd-amdhsa--gfx950"
.text
.globl recurrent_scan__compressed_kv_cla__geglu_ffn__decode_kernel
.p2align 8
.type recurrent_scan__compressed_kv_cla__geglu_ffn__decode_kernel,@function
recurrent_scan__compressed_kv_cla__geglu_ffn__decode_kernel:
    s_cmp_ge_u32 s2, 256
    s_cbranch_scc1 L_exit
    s_load_dwordx16 s[64:79], s[0:1], 0
    s_load_dwordx8 s[80:87], s[0:1], 64
    s_load_dwordx2 s[88:89], s[0:1], 96
    v_readfirstlane_b32 s3, v0
    v_and_b32 v0, 63, v0
    s_nop 2
    s_lshr_b32 s3, s3, 6
    s_cmp_ge_u32 s2, 128
    s_cbranch_scc1 L_roleA
    s_lshr_b32 s24, s2, 5
    s_lshl_b32 s24, s24, 3
    s_and_b32 s28, s2, 7
    s_add_u32 s28, s28, s24
    s_bfe_u32 s29, s2, 0x20003
    s_and_b32 s25, s3, 1
    s_lshl_b32 s25, s25, 3
    v_lshrrev_b32 v6, 4, v0
    v_lshl_add_u32 v7, v6, 1, s25
    v_xor_b32 v7, v7, v0
    v_and_b32 v7, 15, v7
    v_lshlrev_b32 v7, 4, v7
    v_lshl_add_u32 v9, v6, 13, v7
    v_lshlrev_b32 v10, 2, v0
    s_lshr_b32 s24, s3, 1
    s_lshl_b32 s24, s24, 2
    s_add_u32 s24, s24, s25
    s_mul_i32 s25, s29, 160
    s_add_u32 s24, s24, s25
    s_lshl_b32 s24, s24, 13
    s_lshl_b32 s26, s28, 8
    s_add_u32 s30, s24, s26
    s_lshl_b32 s27, s3, 10
    s_add_u32 m0, s27, 8192
    s_mul_i32 s24, s3, 1280
    s_mov_b32 s18, 2560
    s_mov_b32 s19, 0x20000
    s_mov_b32 s10, 5242880
    s_mov_b32 s11, 0x20000
    s_cmp_ge_u32 s3, 2
    s_waitcnt lgkmcnt(0)
    s_mov_b64 s[16:17], s[64:65]
    s_mov_b64 s[8:9], s[68:69]
    s_cbranch_scc1 L_nox
    buffer_load_dword v112, v10, s[16:19], s24 offen offset:0
    buffer_load_dword v113, v10, s[16:19], s24 offen offset:256
    buffer_load_dword v114, v10, s[16:19], s24 offen offset:512
    buffer_load_dword v115, v10, s[16:19], s24 offen offset:768
    buffer_load_dword v116, v10, s[16:19], s24 offen offset:1024
L_nox:
    s_mov_b32 s31, 10
L1_dma:
    buffer_load_dwordx4 v9, s[8:11], s30 offen  lds
    s_add_u32 s30, s30, 131072
    s_add_u32 m0, m0, 4096
    s_sub_u32 s31, s31, 1
    s_cmp_lg_u32 s31, 0
    s_cbranch_scc1 L1_dma
    s_load_dword s20, s[88:89], 0
    s_mov_b64 s[4:5], s[88:89]
    s_mov_b32 s6, 10485760
    s_mov_b32 s7, 0x20000
    s_mov_b64 s[12:13], s[70:71]
    s_mov_b32 s14, 4194304
    s_mov_b32 s15, 0x20000
    s_lshl_b32 s38, s28, 12
    s_add_u32 s38, s38, 1900544
    s_lshl_b32 s24, s29, 10
    s_lshl_b32 s25, s3, 7
    s_add_u32 s24, s24, s25
    s_add_u32 s32, s38, s24
    v_lshlrev_b32 v11, 9, v0
    s_mov_b64 exec, 3
    buffer_load_dword v128, v11, s[4:7], s32 offen sc1
    s_mov_b64 exec, -1
    s_cmp_ge_u32 s3, 2
    s_cbranch_scc1 L2_noln
    s_waitcnt vmcnt(11)
    v_lshlrev_b32 v118, 16, v112
    v_and_b32 v119, 0xffff0000, v112
    v_lshlrev_b32 v120, 16, v113
    v_and_b32 v121, 0xffff0000, v113
    v_lshlrev_b32 v122, 16, v114
    v_and_b32 v123, 0xffff0000, v114
    v_lshlrev_b32 v124, 16, v115
    v_and_b32 v125, 0xffff0000, v115
    v_lshlrev_b32 v126, 16, v116
    v_and_b32 v127, 0xffff0000, v116
    v_pk_add_f32 v[6:7], v[118:119], v[120:121]
    v_pk_add_f32 v[8:9], v[122:123], v[124:125]
    v_pk_add_f32 v[6:7], v[6:7], v[126:127]
    v_pk_add_f32 v[6:7], v[6:7], v[8:9]
    v_add_f32 v6, v6, v7
    s_nop 1
    v_add_f32_dpp v6, v6, v6 row_ror:8 row_mask:0xf bank_mask:0xf
    s_nop 1
    v_add_f32_dpp v6, v6, v6 row_ror:4 row_mask:0xf bank_mask:0xf
    s_nop 1
    v_add_f32_dpp v6, v6, v6 row_ror:2 row_mask:0xf bank_mask:0xf
    s_nop 1
    v_add_f32_dpp v6, v6, v6 row_ror:1 row_mask:0xf bank_mask:0xf
    v_mov_b32 v7, v6
    s_nop 1
    v_permlane16_swap_b32 v6, v7
    s_nop 0
    v_add_f32 v6, v6, v7
    v_mov_b32 v7, v6
    s_nop 1
    v_permlane32_swap_b32 v6, v7
    s_nop 0
    v_add_f32 v6, v6, v7
    v_mul_f32 v6, -0.0015625, v6
    v_pk_add_f32 v[118:119], v[118:119], v[6:7] op_sel_hi:[1,0]
    v_pk_add_f32 v[120:121], v[120:121], v[6:7] op_sel_hi:[1,0]
    v_pk_add_f32 v[122:123], v[122:123], v[6:7] op_sel_hi:[1,0]
    v_pk_add_f32 v[124:125], v[124:125], v[6:7] op_sel_hi:[1,0]
    v_pk_add_f32 v[126:127], v[126:127], v[6:7] op_sel_hi:[1,0]
    v_pk_mul_f32 v[8:9], v[118:119], v[118:119]
    v_pk_fma_f32 v[8:9], v[120:121], v[120:121], v[8:9]
    v_pk_fma_f32 v[8:9], v[122:123], v[122:123], v[8:9]
    v_pk_fma_f32 v[8:9], v[124:125], v[124:125], v[8:9]
    v_pk_fma_f32 v[8:9], v[126:127], v[126:127], v[8:9]
    v_add_f32 v8, v8, v9
    s_nop 1
    v_add_f32_dpp v8, v8, v8 row_ror:8 row_mask:0xf bank_mask:0xf
    s_nop 1
    v_add_f32_dpp v8, v8, v8 row_ror:4 row_mask:0xf bank_mask:0xf
    s_nop 1
    v_add_f32_dpp v8, v8, v8 row_ror:2 row_mask:0xf bank_mask:0xf
    s_nop 1
    v_add_f32_dpp v8, v8, v8 row_ror:1 row_mask:0xf bank_mask:0xf
    v_mov_b32 v7, v8
    s_nop 1
    v_permlane16_swap_b32 v8, v7
    s_nop 0
    v_add_f32 v8, v8, v7
    v_mov_b32 v7, v8
    s_nop 1
    v_permlane32_swap_b32 v8, v7
    s_nop 0
    v_add_f32 v8, v8, v7
    v_mul_f32 v8, 0.0015625, v8
    v_cvt_pk_bf16_f32 v7, v6, v8
    v_and_b32 v8, 0xffff0000, v7
    v_lshlrev_b32 v7, 16, v7
    v_add_f32 v8, 1e-5, v8
    v_cvt_pk_bf16_f32 v8, v8, v8
    v_and_b32 v8, 0xffff0000, v8
    v_sqrt_f32 v8, v8
    v_sub_f32 v6, v7, v6
    v_cvt_pk_bf16_f32 v8, v8, v8
    v_and_b32 v8, 0xffff0000, v8
    v_rcp_f32 v8, v8
    s_mul_i32 s24, s3, 1344
    v_add_u32 v11, s24, v10
    v_mul_f32 v6, v6, v8
    v_pk_fma_f32 v[118:119], v[118:119], v[8:9], v[6:7] op_sel_hi:[1,0,0]
    v_pk_fma_f32 v[120:121], v[120:121], v[8:9], v[6:7] op_sel_hi:[1,0,0]
    v_pk_fma_f32 v[122:123], v[122:123], v[8:9], v[6:7] op_sel_hi:[1,0,0]
    v_pk_fma_f32 v[124:125], v[124:125], v[8:9], v[6:7] op_sel_hi:[1,0,0]
    v_pk_fma_f32 v[126:127], v[126:127], v[8:9], v[6:7] op_sel_hi:[1,0,0]
    v_cvt_pk_bf16_f32 v112, v118, v119
    ds_write_b32 v11, v112 offset:0
    v_cvt_pk_bf16_f32 v113, v120, v121
    ds_write_b32 v11, v113 offset:256
    v_cvt_pk_bf16_f32 v114, v122, v123
    ds_write_b32 v11, v114 offset:512
    v_cvt_pk_bf16_f32 v115, v124, v125
    ds_write_b32 v11, v115 offset:768
    v_cvt_pk_bf16_f32 v116, v126, v127
    ds_write_b32 v11, v116 offset:1024
L2_noln:
    v_lshrrev_b32 v6, 4, v0
    v_and_b32 v7, 15, v0
    v_xor_b32 v8, v6, v7
    v_lshlrev_b32 v8, 4, v8
    v_lshl_add_u32 v16, v6, 13, v8
    v_xor_b32 v17, 64, v16
    v_xor_b32 v18, 0x80, v16
    v_xor_b32 v19, 0xc0, v16
    s_lshl_b32 s24, s29, 2
    s_add_u32 s24, s24, s3
    s_lshl_b32 s24, s24, 18
    s_lshl_b32 s26, s28, 8
    s_add_u32 s30, s24, s26
    s_lshl_b32 s24, s3, 13
    s_add_u32 m0, s24, 49152
    s_add_u32 s39, s30, 0
    buffer_load_dwordx4 v16, s[12:15], s39 offen  lds
    s_add_u32 m0, m0, 0x400
    s_add_u32 s39, s30, 65536
    buffer_load_dwordx4 v17, s[12:15], s39 offen  lds
    s_add_u32 m0, m0, 0x400
    s_add_u32 s39, s30, 131072
    buffer_load_dwordx4 v18, s[12:15], s39 offen  lds
    s_add_u32 m0, m0, 0x400
    s_add_u32 s39, s30, 196608
    buffer_load_dwordx4 v19, s[12:15], s39 offen  lds
    s_add_u32 m0, m0, 0x400
    s_add_u32 s39, s30, 32768
    buffer_load_dwordx4 v16, s[12:15], s39 offen  lds
    s_add_u32 m0, m0, 0x400
    s_add_u32 s39, s30, 98304
    buffer_load_dwordx4 v17, s[12:15], s39 offen  lds
    s_add_u32 m0, m0, 0x400
    s_add_u32 s39, s30, 163840
    buffer_load_dwordx4 v18, s[12:15], s39 offen  lds
    s_add_u32 m0, m0, 0x400
    s_add_u32 s39, s30, 229376
    buffer_load_dwordx4 v19, s[12:15], s39 offen  lds
    s_waitcnt lgkmcnt(0)
    s_getreg_b32 s33, hwreg(HW_REG_XCC_ID, 0, 3)
    s_add_u32 s20, s20, 1
    s_movk_i32 s22, 0xfff
    s_and_b32 s21, s20, 0x1ff
    s_lshl_b32 s26, s33, 9
    s_or_b32 s21, s21, s26
    v_mov_b32 v5, s21
    v_lshl_add_u32 v20, v7, 8, v8
    v_add_u32 v20, s24, v20
    v_xor_b32 v21, 64, v20
    v_xor_b32 v22, 0x80, v20
    v_xor_b32 v23, 0xc0, v20
    v_and_b32 v9, 1, v0
    v_mul_u32_u24 v4, 1344, v9
    v_lshl_add_u32 v4, v6, 4, v4
    v_bfe_u32 v10, v0, 2, 3
    v_lshrrev_b32 v11, 5, v0
    v_lshl_add_u32 v11, v11, 4, v10
    v_and_b32 v13, 3, v0
    v_xor_b32 v12, s3, v10
    v_lshlrev_b32 v12, 5, v12
    v_lshl_add_u32 v12, v11, 8, v12
    v_lshl_add_u32 v130, v13, 3, v12
    v_xor_b32 v131, 0x80, v130
    v_lshrrev_b32 v10, 1, v10
    v_xor_b32 v10, s3, v10
    v_lshlrev_b32 v10, 5, v10
    v_lshl_add_u32 v3, v11, 7, v10
    v_lshl_add_u32 v3, v13, 3, v3
    v_cmp_gt_u32 s[58:59], 2, v7
    s_mul_i32 s24, s29, 320
    v_add_u32 v14, s24, v4
    v_lshlrev_b32 v15, 6, v9
    v_lshl_add_u32 v15, v6, 4, v15
    v_bfe_u32 v11, v0, 1, 1
    v_lshl_add_u32 v136, v11, 9, v15
    v_cmp_eq_u32 s[36:37], 1, v11
    v_lshlrev_b32 v141, 4, v0
    v_bfe_u32 v11, v0, 2, 1
    v_mul_u32_u24 v11, 320, v11
    v_lshrrev_b32 v12, 3, v0
    v_lshl_add_u32 v11, v12, 5, v11
    v_lshl_add_u32 v11, v13, 3, v11
    v_add_u32 v137, s27, v11
    v_mul_u32_u24 v11, 320, v9
    v_lshl_add_u32 v11, v6, 4, v11
    v_add_u32 v138, s27, v11
    v_lshlrev_b32 v11, 8, v9
    v_lshl_add_u32 v11, v6, 4, v11
    s_lshl_b32 s24, s3, 6
    v_add_u32 v139, s24, v11
    v_lshlrev_b32 v11, 4, v7
    v_lshl_add_u32 v140, v6, 15, v11
    s_lshl_b32 s24, s29, 5
    s_add_u32 s24, s24, s28
    s_lshl_b32 s30, s24, 8
    s_add_u32 s30, s30, 131072
    s_lshl_b32 s39, s24, 7
    s_add_u32 s39, s39, 196608
    s_lshr_b32 s24, s3, 1
    s_lshl_b32 s24, s24, 4
    s_and_b32 s25, s3, 1
    s_lshl_b32 s25, s25, 2
    s_add_u32 s24, s24, s25
    v_and_b32 v11, 3, v12
    v_lshrrev_b32 v10, 5, v0
    v_lshl_add_u32 v1, v10, 3, v11
    v_add_u32 v1, s24, v1
    v_and_b32 v12, 6, v12
    v_xor_b32 v12, v12, v0
    v_and_b32 v12, 7, v12
    v_lshlrev_b32 v2, 4, v12
    v_mov_b32 v12, 0
    v_lshlrev_b32 v10, 2, v0
    v_and_b32 v11, 0x7c, v10
    ds_write_b32 v11, v12 offset:8064
    s_mov_b32 s60, 0x000f000f
    s_mov_b32 s61, 0x000f000f
    s_mov_b32 s90, 0.12751743082459868
    s_waitcnt vmcnt(8) lgkmcnt(0)
    s_barrier
    ds_read_b64_tr_b16 v[32:33], v130 offset:8192
    ds_read_b64_tr_b16 v[34:35], v130 offset:10240
    ds_read_b64_tr_b16 v[36:37], v131 offset:8192
    ds_read_b64_tr_b16 v[38:39], v131 offset:10240
    ds_read_b128 v[72:75], v14 offset:0
    ds_read_b64_tr_b16 v[40:41], v130 offset:16384
    ds_read_b64_tr_b16 v[42:43], v130 offset:18432
    ds_read_b64_tr_b16 v[44:45], v131 offset:16384
    ds_read_b64_tr_b16 v[46:47], v131 offset:18432
    ds_read_b128 v[76:79], v14 offset:64
    ds_read_b64_tr_b16 v[48:49], v130 offset:24576
    ds_read_b64_tr_b16 v[50:51], v130 offset:26624
    ds_read_b64_tr_b16 v[52:53], v131 offset:24576
    ds_read_b64_tr_b16 v[54:55], v131 offset:26624
    ds_read_b128 v[80:83], v14 offset:128
    s_waitcnt lgkmcnt(10)
    v_mfma_f32_16x16x32_bf16 v[24:27], v[32:35], v[72:75], 0
    v_mfma_f32_16x16x32_bf16 v[28:31], v[36:39], v[72:75], 0
    ds_read_b64_tr_b16 v[56:57], v130 offset:32768
    ds_read_b64_tr_b16 v[58:59], v130 offset:34816
    ds_read_b64_tr_b16 v[60:61], v131 offset:32768
    ds_read_b64_tr_b16 v[62:63], v131 offset:34816
    ds_read_b128 v[84:87], v14 offset:192
    s_waitcnt lgkmcnt(10)
    v_mfma_f32_16x16x32_bf16 v[24:27], v[40:43], v[76:79], v[24:27]
    v_mfma_f32_16x16x32_bf16 v[28:31], v[44:47], v[76:79], v[28:31]
    ds_read_b64_tr_b16 v[64:65], v130 offset:40960
    ds_read_b64_tr_b16 v[66:67], v130 offset:43008
    ds_read_b64_tr_b16 v[68:69], v131 offset:40960
    ds_read_b64_tr_b16 v[70:71], v131 offset:43008
    ds_read_b128 v[88:91], v14 offset:256
    s_waitcnt lgkmcnt(10)
    v_mfma_f32_16x16x32_bf16 v[24:27], v[48:51], v[80:83], v[24:27]
    v_mfma_f32_16x16x32_bf16 v[28:31], v[52:55], v[80:83], v[28:31]
    s_waitcnt lgkmcnt(5)
    v_mfma_f32_16x16x32_bf16 v[24:27], v[56:59], v[84:87], v[24:27]
    v_mfma_f32_16x16x32_bf16 v[28:31], v[60:63], v[84:87], v[28:31]
    s_waitcnt lgkmcnt(0)
    v_mfma_f32_16x16x32_bf16 v[24:27], v[64:67], v[88:91], v[24:27]
    v_mfma_f32_16x16x32_bf16 v[28:31], v[68:71], v[88:91], v[28:31]
    s_nop 7
    v_cndmask_b32 v132, v24, v28, s[36:37]
    v_cndmask_b32 v133, v25, v29, s[36:37]
    v_cndmask_b32 v134, v26, v30, s[36:37]
    v_cndmask_b32 v135, v27, v31, s[36:37]
    v_bfi_b32 v132, s22, v5, v132
    v_bfi_b32 v133, s22, v5, v133
    v_bfi_b32 v134, s22, v5, v134
    v_bfi_b32 v135, s22, v5, v135
    s_mov_b64 exec, s[60:61]
    buffer_store_dwordx4 v[132:135], v136, s[4:7], s32 offen
    s_mov_b64 exec, -1
    s_mov_b32 s23, 0
L3_qp:
    buffer_load_dwordx4 v[96:99], v141, s[4:7], s38 offen offset:0 sc1
    buffer_load_dwordx4 v[100:103], v141, s[4:7], s38 offen offset:1024 sc1
    buffer_load_dwordx4 v[104:107], v141, s[4:7], s38 offen offset:2048 sc1
    buffer_load_dwordx4 v[108:111], v141, s[4:7], s38 offen offset:3072 sc1
    s_waitcnt vmcnt(4)
    ds_read_b128 v[32:35], v20 offset:49152
    ds_read_b128 v[36:39], v21 offset:49152
    ds_read_b128 v[40:43], v22 offset:49152
    ds_read_b128 v[44:47], v23 offset:49152
    ds_read_b128 v[48:51], v20 offset:53248
    ds_read_b128 v[52:55], v21 offset:53248
    ds_read_b128 v[56:59], v22 offset:53248
    ds_read_b128 v[60:63], v23 offset:53248
    s_waitcnt vmcnt(2)
    v_pk_add_f32 v[112:113], v[96:97], v[100:101]
    v_pk_add_f32 v[114:115], v[98:99], v[102:103]
    s_waitcnt vmcnt(0)
    v_pk_add_f32 v[116:117], v[104:105], v[108:109]
    v_pk_add_f32 v[118:119], v[106:107], v[110:111]
    v_pk_add_f32 v[112:113], v[112:113], v[116:117]
    v_pk_add_f32 v[114:115], v[114:115], v[118:119]
    v_cvt_pk_bf16_f32 v112, v112, v113
    v_cvt_pk_bf16_f32 v113, v114, v115
    ds_write_b64 v137, v[112:113] offset:3072
    ds_read_b128 v[80:83], v138 offset:3072
    ds_read_b128 v[84:87], v138 offset:3136
    ds_read_b128 v[88:91], v138 offset:3200
    ds_read_b128 v[92:95], v138 offset:3264
    v_xor_b32 v13, s21, v96
    v_bitop3_b32 v13, v13, v97, s21 bitop3:0xf6
    v_bitop3_b32 v13, v13, v98, s21 bitop3:0xf6
    v_bitop3_b32 v13, v13, v99, s21 bitop3:0xf6
    v_bitop3_b32 v13, v13, v100, s21 bitop3:0xf6
    v_bitop3_b32 v13, v13, v101, s21 bitop3:0xf6
    v_bitop3_b32 v13, v13, v102, s21 bitop3:0xf6
    v_bitop3_b32 v13, v13, v103, s21 bitop3:0xf6
    v_bitop3_b32 v13, v13, v104, s21 bitop3:0xf6
    v_bitop3_b32 v13, v13, v105, s21 bitop3:0xf6
    v_bitop3_b32 v13, v13, v106, s21 bitop3:0xf6
    v_bitop3_b32 v13, v13, v107, s21 bitop3:0xf6
    v_bitop3_b32 v13, v13, v108, s21 bitop3:0xf6
    v_bitop3_b32 v13, v13, v109, s21 bitop3:0xf6
    v_bitop3_b32 v13, v13, v110, s21 bitop3:0xf6
    v_bitop3_b32 v13, v13, v111, s21 bitop3:0xf6
    v_and_b32 v12, 0x1ff, v13
    v_cmp_ne_u32 vcc, 0, v12
    s_cbranch_vccz L4_ok
    s_add_u32 s23, s23, 1
    s_cmp_lg_u32 s23, 24
    s_cbranch_scc1 L5_nofb
    s_mov_b64 exec, s[60:61]
    buffer_store_dwordx4 v[132:135], v136, s[4:7], s32 offen sc1
    s_mov_b64 exec, -1
L5_nofb:
    s_cmp_lt_u32 s23, 32768
    s_cbranch_scc1 L3_qp
L4_ok:
    s_waitcnt lgkmcnt(3)
    v_mfma_f32_16x16x32_bf16 v[24:27], v[32:35], v[80:83], 0
    v_mfma_f32_16x16x32_bf16 v[28:31], v[48:51], v[80:83], 0
    s_waitcnt lgkmcnt(2)
    v_mfma_f32_16x16x32_bf16 v[24:27], v[36:39], v[84:87], v[24:27]
    v_mfma_f32_16x16x32_bf16 v[28:31], v[52:55], v[84:87], v[28:31]
    s_waitcnt lgkmcnt(1)
    v_mfma_f32_16x16x32_bf16 v[24:27], v[40:43], v[88:91], v[24:27]
    v_mfma_f32_16x16x32_bf16 v[28:31], v[56:59], v[88:91], v[28:31]
    s_waitcnt lgkmcnt(0)
    v_mfma_f32_16x16x32_bf16 v[24:27], v[44:47], v[92:95], v[24:27]
    v_mfma_f32_16x16x32_bf16 v[28:31], v[60:63], v[92:95], v[28:31]
    v_and_b32 v13, 0xe00, v13
    v_cmp_ne_u32 s[62:63], 0, v13
    s_nop 4
    v_pk_mul_f32 v[24:25], v[24:25], s[90:91] op_sel_hi:[1,0]
    v_pk_mul_f32 v[26:27], v[26:27], s[90:91] op_sel_hi:[1,0]
    v_pk_mul_f32 v[28:29], v[28:29], s[90:91] op_sel_hi:[1,0]
    v_pk_mul_f32 v[30:31], v[30:31], s[90:91] op_sel_hi:[1,0]
    v_cvt_pk_bf16_f32 v96, v24, v25
    v_cvt_pk_bf16_f32 v97, v26, v27
    v_cvt_pk_bf16_f32 v98, v28, v29
    v_cvt_pk_bf16_f32 v99, v30, v31
    s_mov_b64 exec, s[58:59]
    ds_write_b128 v139, v[96:99] offset:7168
    s_mov_b64 exec, -1
    s_cmp_lg_u32 s3, 0
    s_waitcnt lgkmcnt(0)
    s_barrier
    s_cbranch_scc1 L6_nopub
    s_mov_b32 exec_hi, 0
    ds_read_b128 v[96:99], v141 offset:7168
    s_waitcnt lgkmcnt(0)
    buffer_store_dwordx4 v[96:99], v140, s[4:7], s30 offen sc1
    v_add3_u32 v13, v96, v97, v98
    v_add_u32 v13, v13, v99
    s_nop 1
    v_add_u32_dpp v13, v13, v13 row_ror:8 row_mask:0xf bank_mask:0xf
    s_nop 1
    v_add_u32_dpp v13, v13, v13 row_ror:4 row_mask:0xf bank_mask:0xf
    s_nop 1
    v_add_u32_dpp v13, v13, v13 row_ror:2 row_mask:0xf bank_mask:0xf
    s_nop 1
    v_add_u32_dpp v13, v13, v13 row_ror:1 row_mask:0xf bank_mask:0xf
    v_add_u32 v13, s20, v13
    buffer_store_dword v13, v10, s[4:7], s39 offen sc1
    s_mov_b64 exec, -1
L6_nopub:
    s_barrier
    s_mov_b64 s[16:17], s[66:67]
    s_mov_b32 s18, 16777216
    s_mov_b32 s19, 0x20000
    s_and_b32 s24, s2, 7
    s_lshl_b32 s24, s24, 21
    s_lshr_b32 s25, s2, 3
    s_lshl_b32 s25, s25, 14
    s_add_u32 s24, s24, s25
    s_lshl_b32 s25, s3, 19
    s_add_u32 s24, s24, s25
    v_lshrrev_b32 v11, 5, v0
    v_bfe_u32 v12, v0, 1, 4
    v_lshlrev_b32 v12, 10, v12
    v_lshl_add_u32 v11, v11, 18, v12
    v_lshl_add_u32 v11, v9, 7, v11
    buffer_load_dword v142, v11, s[16:19], s24 offen offset:256
    s_cmp_eq_u64 s[62:63], 0
    s_cbranch_scc1 L7_noqpwt
    s_mov_b64 exec, s[60:61]
    buffer_store_dwordx4 v[132:135], v136, s[4:7], s32 offen sc1
    s_mov_b64 exec, -1
L7_noqpwt:
    v_mul_u32_u24 v14, 1280, v1
    v_add_u32 v14, v14, v2
    s_add_u32 m0, s27, 8192
    v_lshrrev_b32 v11, 3, v0
    v_and_b32 v12, 7, v0
    v_lshlrev_b32 v12, 4, v12
    v_lshl_add_u32 v15, v11, 13, v12
    s_mul_i32 s24, s3, 81920
    s_and_b32 s25, s2, 63
    s_lshl_b32 s25, s25, 7
    s_add_u32 s92, s24, s25
    s_cmp_ge_u32 s2, 64
    s_cbranch_scc1 L8_F
    s_and_b32 s28, s2, 7
    s_lshl_b32 s28, s28, 2
    s_add_u32 s28, s28, s29
    s_lshr_b32 s29, s2, 5
    s_lshl_b32 s24, s28, 1
    s_add_u32 s24, s24, s29
    s_mul_i32 s30, s24, 81920
    s_lshl_b32 s91, s24, 7
    s_add_u32 s92, s92, 1114112
    s_add_u32 s93, s92, 65536
    s_mov_b64 s[12:13], s[74:75]
    s_mov_b32 s14, 5242880
    s_mov_b32 s15, 0x20000
    s_mov_b64 s[8:9], s[72:73]
    s_mov_b32 s10, 4194304
    s_mov_b32 s11, 0x20000
    s_mov_b32 s31, 10
L11_dma:
    buffer_load_dwordx4 v14, s[12:15], s30 offen  lds
    s_add_u32 s30, s30, 128
    s_add_u32 m0, m0, 4096
    s_sub_u32 s31, s31, 1
    s_cmp_lg_u32 s31, 0
    s_cbranch_scc1 L11_dma
    s_add_u32 s30, s30, 39680
    s_mov_b32 s31, 10
L12_dma:
    buffer_load_dwordx4 v14, s[12:15], s30 offen  lds
    s_add_u32 s30, s30, 128
    s_add_u32 m0, m0, 4096
    s_sub_u32 s31, s31, 1
    s_cmp_lg_u32 s31, 0
    s_cbranch_scc1 L12_dma
    s_and_b32 s24, s3, 1
    s_lshr_b32 s25, s3, 1
    s_lshl_b32 s25, s25, 2
    s_add_u32 s24, s24, s25
    v_lshrrev_b32 v11, 5, v0
    v_lshl_add_u32 v11, v11, 1, s24
    v_bfe_u32 v12, v0, 3, 1
    v_lshl_add_u32 v11, v12, 5, v11
    v_bfe_u32 v12, v0, 4, 1
    v_lshl_add_u32 v11, v12, 4, v11
    v_lshl_add_u32 v11, v11, 13, v2
    s_mov_b32 s31, 8
L13_uv:
    buffer_load_dwordx4 v11, s[8:11], s91 offen  lds
    s_add_u32 s91, s91, 65536
    s_add_u32 m0, m0, 0x1000
    s_sub_u32 s31, s31, 1
    buffer_load_dwordx4 v11, s[8:11], s91 offen  lds
    s_add_u32 s91, s91, 458752
    s_add_u32 m0, m0, 0x1000
    s_cmp_lg_u32 s31, 0
    s_cbranch_scc1 L13_uv
    v_mul_u32_u24 v11, 192, v9
    v_lshl_add_u32 v11, v6, 4, v11
    v_add_u32 v11, 7680, v11
    v_mov_b32 v12, 8064
    v_lshrrev_b32 v13, 1, v7
    v_cmp_eq_u32 vcc, 0, v13
    s_nop 1
    v_cndmask_b32 v16, v12, v11, vcc
    v_cmp_eq_u32 vcc, 1, v13
    s_nop 1
    v_cndmask_b32 v17, v12, v11, vcc
    v_cmp_eq_u32 vcc, 2, v13
    s_nop 1
    v_cndmask_b32 v18, v12, v11, vcc
    v_cmp_eq_u32 vcc, 3, v13
    s_nop 1
    v_cndmask_b32 v19, v12, v11, vcc
    v_cmp_eq_u32 vcc, 4, v13
    s_nop 1
    v_cndmask_b32 v20, v12, v11, vcc
    v_cmp_eq_u32 vcc, 5, v13
    s_nop 1
    v_cndmask_b32 v21, v12, v11, vcc
    v_cmp_eq_u32 vcc, 6, v13
    s_nop 1
    v_cndmask_b32 v22, v12, v11, vcc
    v_cmp_eq_u32 vcc, 7, v13
    s_nop 1
    v_cndmask_b32 v23, v12, v11, vcc
    v_add_u32 v240, 8192, v3
    v_add_u32 v241, 73728, v3
    v_add_u32 v242, 90112, v3
    s_lshl_b32 s30, s28, 12
    s_add_u32 s30, s30, s27
    s_add_u32 s30, s30, 524288
    s_lshr_b32 s24, s3, 1
    s_and_b32 s25, s3, 1
    v_lshlrev_b32 v243, 4, v0
    v_mov_b32 v248, v5
    v_mov_b32 v249, v5
    v_mov_b32 v250, v5
    v_mov_b32 v251, v5
    s_mul_i32 s24, s24, 1088
    s_lshl_b32 s25, s25, 9
    s_add_u32 s24, s24, s25
    v_lshl_add_u32 v245, v0, 3, s24
    v_mul_u32_u24 v246, 1088, v9
    v_lshl_add_u32 v246, v6, 4, v246
    v_mul_u32_u24 v247, 192, v9
    v_lshl_add_u32 v247, v6, 3, v247
    s_lshl_b32 s24, s3, 5
    v_add_u32 v247, s24, v247
    s_lshl_b32 s91, s2, 7
    s_add_u32 s91, s91, 1048576
    s_cmp_eq_u32 s3, 0
    s_cselect_b32 s91, s91, 10485760
    s_waitcnt vmcnt(16)
    s_barrier
    ds_read_b64_tr_b16 v[96:97], v240 offset:0
    ds_read_b64_tr_b16 v[98:99], v240 offset:1024
    ds_read_b64_tr_b16 v[100:101], v240 offset:4096
    ds_read_b64_tr_b16 v[102:103], v240 offset:5120
    ds_read_b64_tr_b16 v[104:105], v240 offset:8192
    ds_read_b64_tr_b16 v[106:107], v240 offset:9216
    ds_read_b64_tr_b16 v[108:109], v240 offset:12288
    ds_read_b64_tr_b16 v[110:111], v240 offset:13312
    ds_read_b64_tr_b16 v[112:113], v240 offset:16384
    ds_read_b64_tr_b16 v[114:115], v240 offset:17408
    ds_read_b64_tr_b16 v[116:117], v240 offset:20480
    ds_read_b64_tr_b16 v[118:119], v240 offset:21504
    ds_read_b64_tr_b16 v[120:121], v240 offset:24576
    ds_read_b64_tr_b16 v[122:123], v240 offset:25600
    ds_read_b64_tr_b16 v[124:125], v240 offset:28672
    ds_read_b64_tr_b16 v[126:127], v240 offset:29696
    ds_read_b64_tr_b16 v[128:129], v240 offset:32768
    ds_read_b64_tr_b16 v[130:131], v240 offset:33792
    ds_read_b64_tr_b16 v[132:133], v240 offset:36864
    ds_read_b64_tr_b16 v[134:135], v240 offset:37888
    ds_read_b64_tr_b16 v[136:137], v240 offset:40960
    ds_read_b64_tr_b16 v[138:139], v240 offset:41984
    ds_read_b64_tr_b16 v[140:141], v240 offset:45056
    ds_read_b64_tr_b16 v[142:143], v240 offset:46080
    ds_read_b64_tr_b16 v[144:145], v240 offset:49152
    ds_read_b64_tr_b16 v[146:147], v240 offset:50176
    ds_read_b64_tr_b16 v[148:149], v240 offset:53248
    ds_read_b64_tr_b16 v[150:151], v240 offset:54272
    ds_read_b64_tr_b16 v[152:153], v240 offset:57344
    ds_read_b64_tr_b16 v[154:155], v240 offset:58368
    ds_read_b64_tr_b16 v[156:157], v240 offset:61440
    ds_read_b64_tr_b16 v[158:159], v240 offset:62464
    ds_read_b64_tr_b16 v[160:161], v241 offset:0
    ds_read_b64_tr_b16 v[162:163], v241 offset:1024
    ds_read_b64_tr_b16 v[164:165], v241 offset:4096
    ds_read_b64_tr_b16 v[166:167], v241 offset:5120
    ds_read_b64_tr_b16 v[168:169], v241 offset:8192
    ds_read_b64_tr_b16 v[170:171], v241 offset:9216
    ds_read_b64_tr_b16 v[172:173], v241 offset:12288
    ds_read_b64_tr_b16 v[174:175], v241 offset:13312
    s_waitcnt vmcnt(0)
    s_barrier
    buffer_load_dwordx4 v[176:179], v243, s[4:7], s30 offen sc1
    ds_read_b64_tr_b16 v[32:33], v242 offset:0
    ds_read_b64_tr_b16 v[34:35], v242 offset:1024
    ds_read_b64_tr_b16 v[36:37], v242 offset:4096
    ds_read_b64_tr_b16 v[38:39], v242 offset:5120
    ds_read_b64_tr_b16 v[40:41], v242 offset:8192
    ds_read_b64_tr_b16 v[42:43], v242 offset:9216
    ds_read_b64_tr_b16 v[44:45], v242 offset:12288
    ds_read_b64_tr_b16 v[46:47], v242 offset:13312
    ds_read_b64_tr_b16 v[48:49], v242 offset:16384
    ds_read_b64_tr_b16 v[50:51], v242 offset:17408
    ds_read_b64_tr_b16 v[52:53], v242 offset:20480
    ds_read_b64_tr_b16 v[54:55], v242 offset:21504
    ds_read_b64_tr_b16 v[56:57], v242 offset:24576
    ds_read_b64_tr_b16 v[58:59], v242 offset:25600
    ds_read_b64_tr_b16 v[60:61], v242 offset:28672
    ds_read_b64_tr_b16 v[62:63], v242 offset:29696
    ds_read_b64_tr_b16 v[64:65], v242 offset:32768
    ds_read_b64_tr_b16 v[66:67], v242 offset:33792
    ds_read_b64_tr_b16 v[68:69], v242 offset:36864
    ds_read_b64_tr_b16 v[70:71], v242 offset:37888
    ds_read_b64_tr_b16 v[72:73], v242 offset:40960
    ds_read_b64_tr_b16 v[74:75], v242 offset:41984
    ds_read_b64_tr_b16 v[76:77], v242 offset:45056
    ds_read_b64_tr_b16 v[78:79], v242 offset:46080
    ds_read_b64_tr_b16 v[80:81], v242 offset:49152
    ds_read_b64_tr_b16 v[82:83], v242 offset:50176
    ds_read_b64_tr_b16 v[84:85], v242 offset:53248
    ds_read_b64_tr_b16 v[86:87], v242 offset:54272
    ds_read_b64_tr_b16 v[88:89], v242 offset:57344
    ds_read_b64_tr_b16 v[90:91], v242 offset:58368
    ds_read_b64_tr_b16 v[92:93], v242 offset:61440
    ds_read_b64_tr_b16 v[94:95], v242 offset:62464
    s_mov_b32 s23, 0
    s_branch L14_clin
L15_cl:
    s_cmp_ge_u32 s23, 64
    s_cselect_b32 s24, 8388608, 0
    s_xor_b32 s30, s30, s24
    buffer_load_dwordx4 v[176:179], v243, s[4:7], s30 offen sc1
L14_clin:
    s_waitcnt vmcnt(0)
    v_cvt_pk_bf16_f32 v196, v176, v177
    v_cvt_pk_bf16_f32 v197, v178, v179
    ds_write_b64 v245, v[196:197] offset:3072
    v_xor_b32 v13, s21, v176
    v_bitop3_b32 v13, v13, v177, s21 bitop3:0xf6
    v_bitop3_b32 v13, v13, v178, s21 bitop3:0xf6
    v_bitop3_b32 v13, v13, v179, s21 bitop3:0xf6
    v_and_b32 v13, 0x1ff, v13
    v_cmp_ne_u32 vcc, 0, v13
    s_cbranch_vccz L16_ok
    s_add_u32 s23, s23, 1
    s_cmp_lt_u32 s23, 32768
    s_cbranch_scc1 L15_cl
L16_ok:
    s_waitcnt lgkmcnt(0)
    s_barrier
    ds_read_b128 v[176:179], v246 offset:3072
    ds_read_b128 v[180:183], v246 offset:3136
    ds_read_b128 v[184:187], v246 offset:3200
    ds_read_b128 v[188:191], v246 offset:3264
    ds_read_b128 v[192:195], v246 offset:3328
    ds_read_b128 v[196:199], v246 offset:3392
    ds_read_b128 v[200:203], v246 offset:3456
    ds_read_b128 v[204:207], v246 offset:3520
    ds_read_b128 v[208:211], v246 offset:3584
    ds_read_b128 v[212:215], v246 offset:3648
    ds_read_b128 v[216:219], v246 offset:3712
    ds_read_b128 v[220:223], v246 offset:3776
    ds_read_b128 v[224:227], v246 offset:3840
    ds_read_b128 v[228:231], v246 offset:3904
    ds_read_b128 v[232:235], v246 offset:3968
    ds_read_b128 v[236:239], v246 offset:4032
    s_waitcnt lgkmcnt(14)
    v_mfma_f32_16x16x32_bf16 v[24:27], v[32:35], v[176:179], 0
    s_waitcnt lgkmcnt(14)
    v_mfma_f32_16x16x32_bf16 v[24:27], v[36:39], v[180:183], v[24:27]
    s_waitcnt lgkmcnt(13)
    v_mfma_f32_16x16x32_bf16 v[24:27], v[40:43], v[184:187], v[24:27]
    s_waitcnt lgkmcnt(12)
    v_mfma_f32_16x16x32_bf16 v[24:27], v[44:47], v[188:191], v[24:27]
    s_waitcnt lgkmcnt(11)
    v_mfma_f32_16x16x32_bf16 v[24:27], v[48:51], v[192:195], v[24:27]
    s_waitcnt lgkmcnt(10)
    v_mfma_f32_16x16x32_bf16 v[24:27], v[52:55], v[196:199], v[24:27]
    s_waitcnt lgkmcnt(9)
    v_mfma_f32_16x16x32_bf16 v[24:27], v[56:59], v[200:203], v[24:27]
    s_waitcnt lgkmcnt(8)
    v_mfma_f32_16x16x32_bf16 v[24:27], v[60:63], v[204:207], v[24:27]
    s_waitcnt lgkmcnt(7)
    v_mfma_f32_16x16x32_bf16 v[24:27], v[64:67], v[208:211], v[24:27]
    s_waitcnt lgkmcnt(6)
    v_mfma_f32_16x16x32_bf16 v[24:27], v[68:71], v[212:215], v[24:27]
    s_waitcnt lgkmcnt(5)
    v_mfma_f32_16x16x32_bf16 v[24:27], v[72:75], v[216:219], v[24:27]
    s_waitcnt lgkmcnt(4)
    v_mfma_f32_16x16x32_bf16 v[24:27], v[76:79], v[220:223], v[24:27]
    s_waitcnt lgkmcnt(3)
    v_mfma_f32_16x16x32_bf16 v[24:27], v[80:83], v[224:227], v[24:27]
    s_waitcnt lgkmcnt(2)
    v_mfma_f32_16x16x32_bf16 v[24:27], v[84:87], v[228:231], v[24:27]
    s_waitcnt lgkmcnt(1)
    v_mfma_f32_16x16x32_bf16 v[24:27], v[88:91], v[232:235], v[24:27]
    s_waitcnt lgkmcnt(0)
    v_mfma_f32_16x16x32_bf16 v[24:27], v[92:95], v[236:239], v[24:27]
    buffer_store_dwordx4 v[248:251], v15, s[4:7], s91 offen sc1
    s_mov_b64 exec, s[58:59]
    s_nop 6
    v_cvt_pk_bf16_f32 v24, v24, v25
    v_cvt_pk_bf16_f32 v25, v26, v27
    ds_write_b64 v247, v[24:25] offset:7680
    s_mov_b64 exec, -1
    s_waitcnt lgkmcnt(0)
    s_barrier
    ds_read_b128 v[176:179], v16 offset:0
    ds_read_b128 v[180:183], v17 offset:0
    ds_read_b128 v[184:187], v18 offset:0
    ds_read_b128 v[188:191], v19 offset:0
    ds_read_b128 v[192:195], v20 offset:0
    ds_read_b128 v[196:199], v21 offset:0
    ds_read_b128 v[200:203], v22 offset:0
    ds_read_b128 v[204:207], v23 offset:0
    ds_read_b128 v[208:211], v16 offset:64
    ds_read_b128 v[212:215], v17 offset:64
    ds_read_b128 v[216:219], v18 offset:64
    ds_read_b128 v[220:223], v19 offset:64
    ds_read_b128 v[224:227], v20 offset:64
    ds_read_b128 v[228:231], v21 offset:64
    ds_read_b128 v[232:235], v22 offset:64
    ds_read_b128 v[236:239], v23 offset:64
    s_waitcnt lgkmcnt(14)
    v_mfma_f32_16x16x32_bf16 v[24:27], v[176:179], v[96:99], 0
    v_mfma_f32_16x16x32_bf16 v[28:31], v[176:179], v[128:131], 0
    s_waitcnt lgkmcnt(14)
    v_mfma_f32_16x16x32_bf16 v[24:27], v[180:183], v[100:103], v[24:27]
    v_mfma_f32_16x16x32_bf16 v[28:31], v[180:183], v[132:135], v[28:31]
    s_waitcnt lgkmcnt(13)
    v_mfma_f32_16x16x32_bf16 v[24:27], v[184:187], v[104:107], v[24:27]
    s_waitcnt lgkmcnt(12)
    v_mfma_f32_16x16x32_bf16 v[24:27], v[188:191], v[108:111], v[24:27]
    s_waitcnt lgkmcnt(11)
    v_mfma_f32_16x16x32_bf16 v[24:27], v[192:195], v[112:115], v[24:27]
    s_waitcnt lgkmcnt(10)
    v_mfma_f32_16x16x32_bf16 v[24:27], v[196:199], v[116:119], v[24:27]
    s_waitcnt lgkmcnt(9)
    v_mfma_f32_16x16x32_bf16 v[24:27], v[200:203], v[120:123], v[24:27]
    s_waitcnt lgkmcnt(8)
    v_mfma_f32_16x16x32_bf16 v[24:27], v[204:207], v[124:127], v[24:27]
    s_waitcnt lgkmcnt(7)
    v_mfma_f32_16x16x32_bf16 v[24:27], v[208:211], v[136:139], v[24:27]
    v_mfma_f32_16x16x32_bf16 v[28:31], v[208:211], v[168:171], v[28:31]
    s_waitcnt lgkmcnt(6)
    v_mfma_f32_16x16x32_bf16 v[24:27], v[212:215], v[140:143], v[24:27]
    v_mfma_f32_16x16x32_bf16 v[28:31], v[212:215], v[172:175], v[28:31]
    s_waitcnt lgkmcnt(5)
    v_mfma_f32_16x16x32_bf16 v[24:27], v[216:219], v[144:147], v[24:27]
    s_waitcnt lgkmcnt(4)
    v_mfma_f32_16x16x32_bf16 v[24:27], v[220:223], v[148:151], v[24:27]
    s_waitcnt lgkmcnt(3)
    v_mfma_f32_16x16x32_bf16 v[24:27], v[224:227], v[152:155], v[24:27]
    s_waitcnt lgkmcnt(2)
    v_mfma_f32_16x16x32_bf16 v[24:27], v[228:231], v[156:159], v[24:27]
    s_waitcnt lgkmcnt(1)
    v_mfma_f32_16x16x32_bf16 v[24:27], v[232:235], v[160:163], v[24:27]
    s_waitcnt lgkmcnt(0)
    v_mfma_f32_16x16x32_bf16 v[24:27], v[236:239], v[164:167], v[24:27]
    v_bfi_b32 v28, s22, v5, v28
    v_bfi_b32 v29, s22, v5, v29
    v_bfi_b32 v30, s22, v5, v30
    v_bfi_b32 v31, s22, v5, v31
    s_mov_b64 exec, 0xffff
    buffer_store_dwordx4 v[28:31], v15, s[4:7], s93 offen sc1
    s_mov_b64 exec, -1
    s_nop 0
    v_bfi_b32 v24, s22, v5, v24
    v_bfi_b32 v25, s22, v5, v25
    v_bfi_b32 v26, s22, v5, v26
    v_bfi_b32 v27, s22, v5, v27
    buffer_store_dwordx4 v[24:27], v15, s[4:7], s92 offen sc1
    s_branch L9_Wend
L8_F:
    s_add_u32 s92, s92, 1441792
    s_add_u32 s93, s92, 65536
    s_bfe_u32 s24, s2, 0x20004
    s_lshl_b32 s24, s24, 3
    s_and_b32 s28, s2, 7
    s_add_u32 s28, s28, s24
    s_cmp_ge_u32 s28, 27
    s_cbranch_scc1 L10_spare
    s_bfe_u32 s29, s2, 0x10003
    s_lshl_b32 s28, s28, 1
    s_add_u32 s28, s28, s29
    s_mul_i32 s30, s28, 40960
    s_mov_b64 s[12:13], s[82:83]
    s_mov_b32 s14, 2211840
    s_mov_b32 s15, 0x20000
    s_lshl_b32 s24, s2, 7
    s_add_u32 s24, s24, 212992
    s_mov_b32 s23, 0
    v_mov_b32 v12, 0
L18_gate:
    buffer_load_dword v13, v12, s[4:7], s24 offen sc1
    s_waitcnt vmcnt(0)
    v_cmp_ne_u32 vcc, s20, v13
    s_cbranch_vccz L19_gateok
    s_add_u32 s23, s23, 1
    s_cmp_lt_u32 s23, 40
    s_cbranch_scc1 L18_gate
L19_gateok:
    s_mov_b32 s31, 10
L20_dma:
    buffer_load_dwordx4 v14, s[12:15], s30 offen  lds
    s_add_u32 s30, s30, 128
    s_add_u32 m0, m0, 4096
    s_sub_u32 s31, s31, 1
    s_cmp_lg_u32 s31, 0
    s_cbranch_scc1 L20_dma
    s_cmp_eq_u32 s29, 0
    s_cselect_b64 s[8:9], s[78:79], s[80:81]
    s_mov_b32 s10, 2211840
    s_mov_b32 s11, 0x20000
    v_mul_u32_u24 v11, 3456, v1
    v_add_u32 v11, v11, v2
    s_lshr_b32 s30, s28, 1
    s_lshl_b32 s30, s30, 7
    s_mov_b32 s31, 20
L21_dma:
    buffer_load_dwordx4 v11, s[8:11], s30 offen  lds
    s_add_u32 s30, s30, 110592
    s_add_u32 m0, m0, 4096
    s_sub_u32 s31, s31, 1
    s_cmp_lg_u32 s31, 0
    s_cbranch_scc1 L21_dma
    v_mul_u32_u24 v11, 192, v9
    v_lshl_add_u32 v11, v6, 4, v11
    v_add_u32 v11, 7680, v11
    v_mov_b32 v12, 8064
    v_lshrrev_b32 v13, 1, v7
    v_cmp_eq_u32 vcc, 0, v13
    s_nop 1
    v_cndmask_b32 v16, v12, v11, vcc
    v_cmp_eq_u32 vcc, 1, v13
    s_nop 1
    v_cndmask_b32 v17, v12, v11, vcc
    v_cmp_eq_u32 vcc, 2, v13
    s_nop 1
    v_cndmask_b32 v18, v12, v11, vcc
    v_cmp_eq_u32 vcc, 3, v13
    s_nop 1
    v_cndmask_b32 v19, v12, v11, vcc
    v_cmp_eq_u32 vcc, 4, v13
    s_nop 1
    v_cndmask_b32 v20, v12, v11, vcc
    v_cmp_eq_u32 vcc, 5, v13
    s_nop 1
    v_cndmask_b32 v21, v12, v11, vcc
    v_cmp_eq_u32 vcc, 6, v13
    s_nop 1
    v_cndmask_b32 v22, v12, v11, vcc
    v_cmp_eq_u32 vcc, 7, v13
    s_nop 1
    v_cndmask_b32 v23, v12, v11, vcc
    v_add_u32 v240, 8192, v3
    v_add_u32 v241, 49152, v3
    v_add_u32 v242, 114688, v3
    v_lshlrev_b32 v243, 4, v7
    s_lshl_b32 s30, s28, 9
    s_and_b32 s25, s3, 1
    s_lshl_b32 s24, s25, 8
    s_add_u32 s30, s30, s24
    s_add_u32 s30, s30, 229376
    s_xor_b32 s39, s30, 512
    s_lshl_b32 s24, s25, 5
    v_lshl_add_u32 v247, v7, 1, s24
    buffer_load_dword v248, v243, s[4:7], s39 offen sc1
    ds_read_b128 v[72:75], v4 offset:0
    ds_read_b128 v[76:79], v4 offset:64
    ds_read_b128 v[80:83], v4 offset:128
    ds_read_b128 v[84:87], v4 offset:192
    ds_read_b128 v[88:91], v4 offset:256
    ds_read_b128 v[92:95], v4 offset:320
    ds_read_b128 v[96:99], v4 offset:384
    ds_read_b128 v[100:103], v4 offset:448
    ds_read_b128 v[104:107], v4 offset:512
    ds_read_b128 v[108:111], v4 offset:576
    ds_read_b128 v[112:115], v4 offset:640
    ds_read_b128 v[116:119], v4 offset:704
    ds_read_b128 v[120:123], v4 offset:768
    ds_read_b128 v[124:127], v4 offset:832
    ds_read_b128 v[128:131], v4 offset:896
    ds_read_b128 v[132:135], v4 offset:960
    ds_read_b128 v[136:139], v4 offset:1024
    ds_read_b128 v[140:143], v4 offset:1088
    ds_read_b128 v[144:147], v4 offset:1152
    ds_read_b128 v[148:151], v4 offset:1216
    s_waitcnt vmcnt(21)
    s_barrier
    ds_read_b64_tr_b16 v[32:33], v240 offset:0
    ds_read_b64_tr_b16 v[34:35], v240 offset:1024
    ds_read_b64_tr_b16 v[36:37], v240 offset:4096
    ds_read_b64_tr_b16 v[38:39], v240 offset:5120
    ds_read_b64_tr_b16 v[40:41], v240 offset:8192
    ds_read_b64_tr_b16 v[42:43], v240 offset:9216
    ds_read_b64_tr_b16 v[44:45], v240 offset:12288
    ds_read_b64_tr_b16 v[46:47], v240 offset:13312
    ds_read_b64_tr_b16 v[48:49], v240 offset:16384
    ds_read_b64_tr_b16 v[50:51], v240 offset:17408
    ds_read_b64_tr_b16 v[52:53], v240 offset:20480
    ds_read_b64_tr_b16 v[54:55], v240 offset:21504
    ds_read_b64_tr_b16 v[56:57], v240 offset:24576
    ds_read_b64_tr_b16 v[58:59], v240 offset:25600
    ds_read_b64_tr_b16 v[60:61], v240 offset:28672
    ds_read_b64_tr_b16 v[62:63], v240 offset:29696
    ds_read_b64_tr_b16 v[64:65], v240 offset:32768
    ds_read_b64_tr_b16 v[66:67], v240 offset:33792
    ds_read_b64_tr_b16 v[68:69], v240 offset:36864
    ds_read_b64_tr_b16 v[70:71], v240 offset:37888
    s_waitcnt vmcnt(6)
    s_barrier
    ds_read_b64_tr_b16 v[152:153], v241 offset:0
    ds_read_b64_tr_b16 v[154:155], v241 offset:1024
    ds_read_b64_tr_b16 v[156:157], v241 offset:4096
    ds_read_b64_tr_b16 v[158:159], v241 offset:5120
    ds_read_b64_tr_b16 v[160:161], v241 offset:8192
    ds_read_b64_tr_b16 v[162:163], v241 offset:9216
    ds_read_b64_tr_b16 v[164:165], v241 offset:12288
    ds_read_b64_tr_b16 v[166:167], v241 offset:13312
    ds_read_b64_tr_b16 v[168:169], v241 offset:16384
    ds_read_b64_tr_b16 v[170:171], v241 offset:17408
    ds_read_b64_tr_b16 v[172:173], v241 offset:20480
    ds_read_b64_tr_b16 v[174:175], v241 offset:21504
    ds_read_b64_tr_b16 v[176:177], v241 offset:24576
    ds_read_b64_tr_b16 v[178:179], v241 offset:25600
    s_waitcnt lgkmcnt(12)
    v_mfma_f32_16x16x32_bf16 v[24:27], v[72:75], v[152:155], 0
    ds_read_b64_tr_b16 v[180:181], v241 offset:28672
    ds_read_b64_tr_b16 v[182:183], v241 offset:29696
    s_waitcnt lgkmcnt(12)
    v_mfma_f32_16x16x32_bf16 v[24:27], v[76:79], v[156:159], v[24:27]
    ds_read_b64_tr_b16 v[184:185], v241 offset:32768
    ds_read_b64_tr_b16 v[186:187], v241 offset:33792
    s_waitcnt lgkmcnt(12)
    v_mfma_f32_16x16x32_bf16 v[24:27], v[80:83], v[160:163], v[24:27]
    ds_read_b64_tr_b16 v[188:189], v241 offset:36864
    ds_read_b64_tr_b16 v[190:191], v241 offset:37888
    s_waitcnt lgkmcnt(12)
    v_mfma_f32_16x16x32_bf16 v[24:27], v[84:87], v[164:167], v[24:27]
    ds_read_b64_tr_b16 v[192:193], v241 offset:40960
    ds_read_b64_tr_b16 v[194:195], v241 offset:41984
    s_waitcnt lgkmcnt(12)
    v_mfma_f32_16x16x32_bf16 v[24:27], v[88:91], v[168:171], v[24:27]
    ds_read_b64_tr_b16 v[196:197], v241 offset:45056
    ds_read_b64_tr_b16 v[198:199], v241 offset:46080
    s_waitcnt lgkmcnt(12)
    v_mfma_f32_16x16x32_bf16 v[24:27], v[92:95], v[172:175], v[24:27]
    ds_read_b64_tr_b16 v[200:201], v241 offset:49152
    ds_read_b64_tr_b16 v[202:203], v241 offset:50176
    s_waitcnt lgkmcnt(12)
    v_mfma_f32_16x16x32_bf16 v[24:27], v[96:99], v[176:179], v[24:27]
    ds_read_b64_tr_b16 v[204:205], v241 offset:53248
    ds_read_b64_tr_b16 v[206:207], v241 offset:54272
    s_waitcnt lgkmcnt(12)
    v_mfma_f32_16x16x32_bf16 v[24:27], v[100:103], v[180:183], v[24:27]
    ds_read_b64_tr_b16 v[208:209], v241 offset:57344
    ds_read_b64_tr_b16 v[210:211], v241 offset:58368
    s_waitcnt lgkmcnt(12)
    v_mfma_f32_16x16x32_bf16 v[24:27], v[104:107], v[184:187], v[24:27]
    s_waitcnt lgkmcnt(10)
    v_mfma_f32_16x16x32_bf16 v[24:27], v[108:111], v[188:191], v[24:27]
    s_waitcnt lgkmcnt(8)
    v_mfma_f32_16x16x32_bf16 v[24:27], v[112:115], v[192:195], v[24:27]
    s_waitcnt lgkmcnt(6)
    v_mfma_f32_16x16x32_bf16 v[24:27], v[116:119], v[196:199], v[24:27]
    s_waitcnt lgkmcnt(4)
    v_mfma_f32_16x16x32_bf16 v[24:27], v[120:123], v[200:203], v[24:27]
    s_waitcnt lgkmcnt(2)
    v_mfma_f32_16x16x32_bf16 v[24:27], v[124:127], v[204:207], v[24:27]
    s_waitcnt lgkmcnt(0)
    v_mfma_f32_16x16x32_bf16 v[24:27], v[128:131], v[208:211], v[24:27]
    s_waitcnt vmcnt(1)
    s_barrier
    ds_read_b64_tr_b16 v[212:213], v241 offset:61440
    ds_read_b64_tr_b16 v[214:215], v241 offset:62464
    ds_read_b64_tr_b16 v[216:217], v242 offset:0
    ds_read_b64_tr_b16 v[218:219], v242 offset:1024
    ds_read_b64_tr_b16 v[220:221], v242 offset:4096
    ds_read_b64_tr_b16 v[222:223], v242 offset:5120
    ds_read_b64_tr_b16 v[224:225], v242 offset:8192
    ds_read_b64_tr_b16 v[226:227], v242 offset:9216
    ds_read_b64_tr_b16 v[228:229], v242 offset:12288
    ds_read_b64_tr_b16 v[230:231], v242 offset:13312
    s_waitcnt lgkmcnt(8)
    v_mfma_f32_16x16x32_bf16 v[24:27], v[132:135], v[212:215], v[24:27]
    s_waitcnt lgkmcnt(6)
    v_mfma_f32_16x16x32_bf16 v[24:27], v[136:139], v[216:219], v[24:27]
    s_waitcnt lgkmcnt(4)
    v_mfma_f32_16x16x32_bf16 v[24:27], v[140:143], v[220:223], v[24:27]
    s_waitcnt lgkmcnt(2)
    v_mfma_f32_16x16x32_bf16 v[24:27], v[144:147], v[224:227], v[24:27]
    s_waitcnt lgkmcnt(0)
    v_mfma_f32_16x16x32_bf16 v[24:27], v[148:151], v[228:231], v[24:27]
    s_lshr_b32 s24, s3, 1
    s_cmp_eq_u32 s24, s29
    s_cbranch_scc1 L22_keep
    s_nop 4
    v_bfi_b32 v24, s22, v5, v24
    v_bfi_b32 v25, s22, v5, v25
    v_bfi_b32 v26, s22, v5, v26
    v_bfi_b32 v27, s22, v5, v27
    s_mov_b64 exec, 0xffff
    buffer_store_dwordx4 v[24:27], v243, s[4:7], s30 offen
    s_xor_b32 s30, s30, 8388608
    buffer_store_dwordx4 v[24:27], v243, s[4:7], s30 offen sc1
    s_mov_b64 exec, -1
    s_branch L23_fjoin
L22_keep:
    s_mov_b32 s23, 0
L24_fx:
    s_cmp_ge_u32 s23, 24
    s_cselect_b32 s24, 8388608, 0
    s_xor_b32 s39, s39, s24
    buffer_load_dwordx4 v[28:31], v243, s[4:7], s39 offen sc1
    s_waitcnt vmcnt(0)
    v_xor_b32 v13, s21, v28
    v_bitop3_b32 v13, v13, v29, s21 bitop3:0xf6
    v_bitop3_b32 v13, v13, v30, s21 bitop3:0xf6
    v_bitop3_b32 v13, v13, v31, s21 bitop3:0xf6
    v_and_b32 v13, 0x1ff, v13
    v_cmp_ne_u32 vcc, 0, v13
    s_cbranch_vccz L25_ok
    s_add_u32 s23, s23, 1
    s_cmp_lt_u32 s23, 32768
    s_cbranch_scc1 L24_fx
L25_ok:
    s_cmp_eq_u32 s29, 0
    s_cselect_b64 vcc, -1, 0
    s_mov_b32 s24, -0.1029432395800235
    v_mov_b32 v11, -2.302208198144325
    v_cndmask_b32 v72, v28, v24, vcc
    v_cndmask_b32 v76, v24, v28, vcc
    v_cndmask_b32 v73, v29, v25, vcc
    v_cndmask_b32 v77, v25, v29, vcc
    v_mul_f32 v80, v72, v72
    v_mul_f32 v81, v73, v73
    v_fma_f32 v80, v80, s24, v11
    v_fma_f32 v81, v81, s24, v11
    v_mul_f32 v80, v80, v72
    v_mul_f32 v81, v81, v73
    v_exp_f32 v80, v80
    v_exp_f32 v81, v81
    s_nop 0
    v_add_f32 v80, 1.0, v80
    v_add_f32 v81, 1.0, v81
    v_rcp_f32 v80, v80
    v_rcp_f32 v81, v81
    s_nop 0
    v_mul_f32 v72, v72, v80
    v_mul_f32 v73, v73, v81
    v_mul_f32 v72, v72, v76
    v_mul_f32 v73, v73, v77
    v_cvt_pk_bf16_f32 v72, v72, v73
    ds_write_b16 v247, v72 offset:7680
    ds_write_b16_d16_hi v247, v72 offset:7872
L23_fjoin:
    s_waitcnt lgkmcnt(0)
    s_barrier
    ds_read_b128 v[152:155], v16 offset:0
    ds_read_b128 v[156:159], v17 offset:0
    ds_read_b128 v[160:163], v18 offset:0
    ds_read_b128 v[164:167], v19 offset:0
    ds_read_b128 v[168:171], v20 offset:0
    ds_read_b128 v[172:175], v21 offset:0
    ds_read_b128 v[176:179], v22 offset:0
    ds_read_b128 v[180:183], v23 offset:0
    s_waitcnt lgkmcnt(7)
    v_mfma_f32_16x16x32_bf16 v[24:27], v[152:155], v[32:35], 0
    v_mfma_f32_16x16x32_bf16 v[28:31], v[152:155], v[64:67], 0
    s_waitcnt lgkmcnt(6)
    v_mfma_f32_16x16x32_bf16 v[24:27], v[156:159], v[36:39], v[24:27]
    v_mfma_f32_16x16x32_bf16 v[28:31], v[156:159], v[68:71], v[28:31]
    s_waitcnt lgkmcnt(5)
    v_mfma_f32_16x16x32_bf16 v[24:27], v[160:163], v[40:43], v[24:27]
    s_waitcnt lgkmcnt(4)
    v_mfma_f32_16x16x32_bf16 v[24:27], v[164:167], v[44:47], v[24:27]
    s_waitcnt lgkmcnt(3)
    v_mfma_f32_16x16x32_bf16 v[24:27], v[168:171], v[48:51], v[24:27]
    s_waitcnt lgkmcnt(2)
    v_mfma_f32_16x16x32_bf16 v[24:27], v[172:175], v[52:55], v[24:27]
    s_waitcnt lgkmcnt(1)
    v_mfma_f32_16x16x32_bf16 v[24:27], v[176:179], v[56:59], v[24:27]
    s_waitcnt lgkmcnt(0)
    v_mfma_f32_16x16x32_bf16 v[24:27], v[180:183], v[60:63], v[24:27]
    v_bfi_b32 v28, s22, v5, v28
    v_bfi_b32 v29, s22, v5, v29
    v_bfi_b32 v30, s22, v5, v30
    v_bfi_b32 v31, s22, v5, v31
    s_mov_b64 exec, 0xffff
    buffer_store_dwordx4 v[28:31], v15, s[4:7], s93 offen sc1
    s_mov_b64 exec, -1
    s_nop 0
    v_bfi_b32 v24, s22, v5, v24
    v_bfi_b32 v25, s22, v5, v25
    v_bfi_b32 v26, s22, v5, v26
    v_bfi_b32 v27, s22, v5, v27
    buffer_store_dwordx4 v[24:27], v15, s[4:7], s92 offen sc1
    s_branch L9_Wend
L10_spare:
    v_mov_b32 v24, 0
    v_mov_b32 v25, 0
    v_mov_b32 v26, 0
    v_mov_b32 v27, 0
    v_mov_b32 v28, 0
    v_mov_b32 v29, 0
    v_mov_b32 v30, 0
    v_mov_b32 v31, 0
    v_bfi_b32 v28, s22, v5, v28
    v_bfi_b32 v29, s22, v5, v29
    v_bfi_b32 v30, s22, v5, v30
    v_bfi_b32 v31, s22, v5, v31
    s_mov_b64 exec, 0xffff
    buffer_store_dwordx4 v[28:31], v15, s[4:7], s93 offen sc1
    s_mov_b64 exec, -1
    s_nop 0
    v_bfi_b32 v24, s22, v5, v24
    v_bfi_b32 v25, s22, v5, v25
    v_bfi_b32 v26, s22, v5, v26
    v_bfi_b32 v27, s22, v5, v27
    buffer_store_dwordx4 v[24:27], v15, s[4:7], s92 offen sc1
L9_Wend:
    s_endpgm
L_exit:
    s_endpgm
    .p2align 6
L_roleA:
    s_and_b32 s34, s2, 7
    s_bfe_u32 s35, s2, 0x40003
    v_lshrrev_b32 v6, 4, v0
    v_and_b32 v7, 15, v0
    v_lshlrev_b32 v8, 2, v6
    v_xor_b32 v8, v8, v7
    v_lshlrev_b32 v8, 4, v8
    v_lshl_add_u32 v252, v6, 10, v8
    v_xor_b32 v253, 0x1010, v252
    v_xor_b32 v254, 0x2020, v252
    v_xor_b32 v255, 0x3030, v252
    s_lshl_b32 s24, s34, 21
    s_lshl_b32 s90, s35, 14
    s_add_u32 s90, s90, s24
    s_lshl_b32 s24, s3, 19
    s_add_u32 s90, s90, s24
    s_lshl_b32 s27, s3, 10
    s_lshl_b32 s93, s3, 13
    s_mov_b32 m0, s93
    s_lshl_b32 s38, s35, 2
    s_add_u32 s38, s38, s3
    s_waitcnt lgkmcnt(0)
    s_mov_b64 s[8:9], s[66:67]
    s_mov_b32 s10, 16777216
    s_mov_b32 s11, 0x20000
    s_getpc_b64 s[60:61]
L_pc:
    s_sub_u32 s60, s60, L_pc-recurrent_scan__compressed_kv_cla__geglu_ffn__decode_kernel
    s_subb_u32 s61, s61, 0
    s_mul_i32 s24, s38, 384
    v_lshl_add_u32 v10, v0, 7, s24
    v_min_u32 v10, L_codeend-recurrent_scan__compressed_kv_cla__geglu_ffn__decode_kernel-4, v10
    s_mov_b64 exec, 7
    global_load_dword v230, v10, s[60:61]
    s_mov_b64 exec, -1
    s_mov_b32 s30, s90
    buffer_load_dwordx4 v252, s[8:11], s30 offen nt lds
    s_waitcnt vmcnt(1)
    s_add_u32 m0, s93, 1024
    s_nop 0
    buffer_load_dwordx4 v253, s[8:11], s30 offen nt lds
    s_load_dword s20, s[88:89], 0
    s_mov_b64 s[4:5], s[88:89]
    s_mov_b32 s6, 10485760
    s_mov_b32 s7, 0x20000
    s_mov_b64 s[12:13], s[72:73]
    s_mov_b32 s14, 4194304
    s_mov_b32 s15, 0x20000
    s_lshl_b32 s24, s3, 4
    v_xor_b32 v2, s24, v8
    v_lshl_add_u32 v2, v6, 8, v2
    v_add_u32 v2, s27, v2
    v_lshrrev_b32 v10, 2, v0
    v_lshlrev_b32 v232, 9, v10
    v_lshlrev_b32 v10, 4, v10
    v_and_b32 v13, 3, v0
    v_lshl_add_u32 v232, v13, 4, v232
    s_lshl_b32 s24, s3, 2
    v_add3_u32 v10, v10, v13, s24
    v_lshlrev_b32 v4, 7, v10
    s_lshr_b32 s24, s34, 2
    s_lshl_b32 s39, s24, 6
    s_add_u32 s39, s39, 196608
    s_lshl_b32 s91, s24, 15
    s_add_u32 s91, s91, 131072
    v_lshlrev_b32 v3, 4, v0
    v_add_u32 v235, 4096, v3
    v_add_u32 v14, 131072, v3
    v_add_u32 v248, s27, v14
    v_mov_b32 v16, 0
    v_lshlrev_b32 v249, 7, v0
    s_lshl_b32 s24, s34, 6
    s_add_u32 s24, s24, s38
    s_lshl_b32 s28, s24, 13
    s_add_u32 s28, s28, 2097152
    s_lshl_b32 s32, s24, 8
    s_add_u32 s32, s32, 393216
    s_lshr_b32 s29, s24, 2
    s_lshl_b32 s29, s29, 9
    s_add_u32 s29, s29, 262144
    s_cmp_eq_u32 s3, 0
    s_cselect_b32 s29, s29, 10485760
    v_lshlrev_b32 v251, 2, v0
    v_lshlrev_b32 v229, 10, v0
    v_bfe_u32 v15, v0, 2, 2
    v_lshl_or_b32 v26, v13, 2, v15
    v_lshrrev_b32 v11, 5, v0
    v_xor_b32 v26, v26, v11
    v_lshlrev_b32 v26, 4, v26
    v_and_b32 v12, 31, v0
    v_lshl_add_u32 v26, v12, 8, v26
    v_add_u32 v18, s93, v26
    v_add_u32 v26, 131072, v26
    v_add_u32 v34, 0x10000, v18
    v_bfe_u32 v92, v0, 4, 1
    v_lshrrev_b32 v93, 1, v13
    v_lshl_or_b32 v92, v92, 1, v93
    v_xor_b32 v92, v92, v11
    v_lshl_or_b32 v92, v15, 2, v92
    v_lshlrev_b32 v92, 4, v92
    v_and_b32 v93, 1, v0
    v_lshl_add_u32 v92, v93, 3, v92
    v_lshl_add_u32 v234, v11, 2, v15
    v_lshl_add_u32 v92, v234, 8, v92
    v_lshlrev_b32 v234, 2, v234
    s_mul_i32 s24, s3, 40960
    v_add_u32 v92, s24, v92
    v_lshlrev_b32 v240, 2, v12
    v_add_u32 v240, 147456, v240
    s_lshl_b32 s24, s3, 7
    v_add_u32 v241, s24, v240
    s_lshl_b32 s24, s3, 11
    v_add_u32 v242, s24, v14
    v_xor_b32 v243, 0x800, v242
    v_xor_b32 v244, 0x1000, v242
    v_xor_b32 v245, 0x1800, v242
    v_lshlrev_b32 v233, 4, v12
    v_lshl_add_u32 v233, v11, 15, v233
    v_lshlrev_b32 v10, 4, v93
    v_mov_b32 v14, 0xffff
    v_lshlrev_b32 v10, v10, v14
    v_lshrrev_b32 v12, 3, v0
    v_xor_b32 v14, v12, v0
    v_and_b32 v14, 2, v14
    v_cmp_eq_u32 vcc, 0, v14
    v_lshlrev_b32 v247, 2, v6
    s_lshl_b32 s24, s3, 8
    v_cndmask_b32 v10, 0, v10, vcc
    s_add_u32 s24, s24, 131072
    v_add_u32 v246, s24, v251
    s_lshl_b32 s24, s3, 5
    s_add_u32 s24, s24, 135168
    v_lshl_add_u32 v42, v13, 3, s24
    v_lshlrev_b32 v43, 3, v6
    v_add_u32 v43, 135168, v43
    v_and_b32 v14, 7, v0
    v_lshlrev_b32 v14, 7, v14
    v_lshl_add_u32 v250, v12, 13, v14
    v_cmp_eq_u32 vcc, 0, v15
    s_nop 1
    v_cndmask_b32 v236, 0, v10, vcc
    v_cmp_eq_u32 vcc, 1, v15
    s_nop 1
    v_cndmask_b32 v237, 0, v10, vcc
    v_cmp_eq_u32 vcc, 2, v15
    s_nop 1
    v_cndmask_b32 v238, 0, v10, vcc
    v_cmp_eq_u32 vcc, 3, v15
    s_nop 1
    v_cndmask_b32 v239, 0, v10, vcc
    s_waitcnt lgkmcnt(0)
    s_getreg_b32 s33, hwreg(HW_REG_XCC_ID, 0, 3)
    s_add_u32 s20, s20, 1
    s_movk_i32 s22, 0xfff
    s_and_b32 s21, s20, 0x1ff
    s_lshl_b32 s26, s33, 9
    s_or_b32 s21, s21, s26
    v_mov_b32 v5, s21
    s_waitcnt vmcnt(1)
    s_add_u32 m0, s93, 2048
    s_nop 0
    buffer_load_dwordx4 v254, s[8:11], s30 offen nt lds
    v_xor_b32 v19, 32, v18
    v_xor_b32 v27, 32, v26
    v_xor_b32 v35, 32, v34
    v_xor_b32 v20, 64, v18
    v_xor_b32 v28, 64, v26
    v_xor_b32 v36, 64, v34
    v_xor_b32 v21, 96, v18
    v_xor_b32 v29, 96, v26
    v_xor_b32 v37, 96, v34
    v_xor_b32 v22, 128, v18
    v_xor_b32 v30, 128, v26
    v_xor_b32 v38, 128, v34
    v_xor_b32 v23, 160, v18
    v_xor_b32 v31, 160, v26
    v_xor_b32 v39, 160, v34
    v_xor_b32 v24, 192, v18
    v_xor_b32 v32, 192, v26
    v_xor_b32 v40, 192, v34
    v_xor_b32 v25, 224, v18
    v_xor_b32 v33, 224, v26
    v_xor_b32 v41, 224, v34
    v_xor_b32 v93, 32, v92
    v_xor_b32 v94, 64, v92
    v_xor_b32 v95, 96, v92
    v_xor_b32 v96, 128, v92
    v_xor_b32 v97, 160, v92
    v_xor_b32 v98, 192, v92
    v_xor_b32 v99, 224, v92
    v_xor_b32 v100, 8192, v92
    v_xor_b32 v101, 8224, v92
    v_xor_b32 v102, 8256, v92
    v_xor_b32 v103, 8288, v92
    v_xor_b32 v104, 8320, v92
    v_xor_b32 v105, 8352, v92
    v_xor_b32 v106, 8384, v92
    v_xor_b32 v107, 8416, v92
    v_xor_b32 v108, 16384, v92
    v_xor_b32 v109, 16416, v92
    v_xor_b32 v110, 16448, v92
    v_xor_b32 v111, 16480, v92
    v_xor_b32 v112, 16512, v92
    v_xor_b32 v113, 16544, v92
    v_xor_b32 v114, 16576, v92
    v_xor_b32 v115, 16608, v92
    v_xor_b32 v116, 24576, v92
    v_xor_b32 v117, 24608, v92
    v_xor_b32 v118, 24640, v92
    v_xor_b32 v119, 24672, v92
    v_xor_b32 v120, 24704, v92
    v_xor_b32 v121, 24736, v92
    v_xor_b32 v122, 24768, v92
    v_xor_b32 v123, 24800, v92
    s_waitcnt vmcnt(1)
    s_add_u32 m0, s93, 3072
    s_nop 0
    buffer_load_dwordx4 v255, s[8:11], s30 offen nt lds
    s_waitcnt vmcnt(1)
    s_add_u32 m0, s93, 4096
    s_add_u32 s30, s90, 262144
    buffer_load_dwordx4 v252, s[8:11], s30 offen nt lds
    s_waitcnt vmcnt(7)
    s_add_u32 m0, s93, 5120
    s_nop 0
    buffer_load_dwordx4 v253, s[8:11], s30 offen nt lds
    s_waitcnt vmcnt(7)
    s_add_u32 m0, s93, 6144
    s_nop 0
    buffer_load_dwordx4 v254, s[8:11], s30 offen nt lds
    s_waitcnt vmcnt(7)
    s_add_u32 m0, s93, 7168
    s_nop 0
    buffer_load_dwordx4 v255, s[8:11], s30 offen nt lds
    s_waitcnt vmcnt(7)
    s_add_u32 m0, s93, 65536
    s_add_u32 s30, s90, 512
    buffer_load_dwordx4 v252, s[8:11], s30 offen nt lds
    s_waitcnt vmcnt(7)
    s_add_u32 m0, s93, 66560
    s_nop 0
    buffer_load_dwordx4 v253, s[8:11], s30 offen nt lds
    s_waitcnt vmcnt(7)
    s_add_u32 m0, s93, 67584
    s_nop 0
    buffer_load_dwordx4 v254, s[8:11], s30 offen nt lds
    s_waitcnt vmcnt(7)
    s_add_u32 m0, s93, 68608
    s_nop 0
    buffer_load_dwordx4 v255, s[8:11], s30 offen nt lds
    s_waitcnt vmcnt(7)
    s_add_u32 m0, s93, 69632
    s_add_u32 s30, s90, 262656
    buffer_load_dwordx4 v252, s[8:11], s30 offen nt lds
    s_waitcnt vmcnt(7)
    s_add_u32 m0, s93, 70656
    s_nop 0
    buffer_load_dwordx4 v253, s[8:11], s30 offen nt lds
    s_waitcnt vmcnt(7)
    s_add_u32 m0, s93, 71680
    s_nop 0
    buffer_load_dwordx4 v254, s[8:11], s30 offen nt lds
    s_waitcnt vmcnt(7)
    ds_read_b128 a[0:3], v18 offset:0
    s_add_u32 m0, s93, 72704
    s_nop 0
    buffer_load_dwordx4 v255, s[8:11], s30 offen nt lds
    s_waitcnt vmcnt(7)
    ds_read_b128 a[4:7], v19 offset:0
    s_add_u32 m0, s93, 98304
    s_add_u32 s30, s90, 768
    buffer_load_dwordx4 v252, s[8:11], s30 offen nt lds
    s_waitcnt vmcnt(7)
    ds_read_b128 a[8:11], v20 offset:0
    s_add_u32 m0, s93, 99328
    s_nop 0
    buffer_load_dwordx4 v253, s[8:11], s30 offen nt lds
    s_waitcnt vmcnt(7)
    ds_read_b128 a[12:15], v21 offset:0
    s_add_u32 m0, s93, 100352
    s_nop 0
    buffer_load_dwordx4 v254, s[8:11], s30 offen nt lds
    s_waitcnt vmcnt(7)
    ds_read_b128 a[16:19], v22 offset:0
    s_add_u32 m0, s93, 101376
    s_nop 0
    buffer_load_dwordx4 v255, s[8:11], s30 offen nt lds
    s_waitcnt vmcnt(7)
    ds_read_b128 a[20:23], v23 offset:0
    s_add_u32 m0, s93, 102400
    s_add_u32 s30, s90, 262912
    buffer_load_dwordx4 v252, s[8:11], s30 offen nt lds
    s_waitcnt vmcnt(7)
    ds_read_b128 a[24:27], v24 offset:0
    s_add_u32 m0, s93, 103424
    s_nop 0
    buffer_load_dwordx4 v253, s[8:11], s30 offen nt lds
    s_waitcnt vmcnt(7)
    ds_read_b128 a[28:31], v25 offset:0
    s_add_u32 m0, s93, 104448
    s_nop 0
    buffer_load_dwordx4 v254, s[8:11], s30 offen nt lds
    s_waitcnt vmcnt(7)
    ds_read_b128 a[32:35], v34 offset:0
    s_add_u32 m0, s93, 105472
    s_nop 0
    buffer_load_dwordx4 v255, s[8:11], s30 offen nt lds
    s_waitcnt vmcnt(7)
    ds_read_b128 a[36:39], v35 offset:0
    s_add_u32 m0, s93, 32768
    s_add_u32 s30, s90, 256
    buffer_load_dwordx4 v252, s[8:11], s30 offen nt lds
    s_waitcnt vmcnt(7)
    ds_read_b128 a[40:43], v36 offset:0
    s_add_u32 m0, s93, 33792
    s_nop 0
    buffer_load_dwordx4 v253, s[8:11], s30 offen nt lds
    s_waitcnt vmcnt(7)
    ds_read_b128 a[44:47], v37 offset:0
    s_add_u32 m0, s93, 34816
    s_nop 0
    buffer_load_dwordx4 v254, s[8:11], s30 offen nt lds
    s_waitcnt vmcnt(7)
    ds_read_b128 a[48:51], v38 offset:0
    s_add_u32 m0, s93, 35840
    s_nop 0
    buffer_load_dwordx4 v255, s[8:11], s30 offen nt lds
    s_waitcnt vmcnt(7)
    ds_read_b128 a[52:55], v39 offset:0
    s_add_u32 m0, s93, 36864
    s_add_u32 s30, s90, 262400
    buffer_load_dwordx4 v252, s[8:11], s30 offen nt lds
    s_waitcnt vmcnt(7)
    ds_read_b128 a[56:59], v40 offset:0
    s_add_u32 m0, s93, 37888
    s_nop 0
    buffer_load_dwordx4 v253, s[8:11], s30 offen nt lds
    s_waitcnt vmcnt(7)
    ds_read_b128 a[60:63], v41 offset:0
    s_add_u32 m0, s93, 38912
    s_nop 0
    buffer_load_dwordx4 v254, s[8:11], s30 offen nt lds
    s_waitcnt vmcnt(7)
    s_add_u32 m0, s93, 39936
    s_nop 0
    buffer_load_dwordx4 v255, s[8:11], s30 offen nt lds
    s_waitcnt vmcnt(7)
    s_mov_b32 s23, 0
L27_qa:
    s_mov_b32 s30, s91
    s_add_u32 m0, s27, 131072
    s_mov_b32 s31, 8
L28_dma:
    buffer_load_dwordx4 v2, s[4:7], s30 offen sc1 lds
    s_add_u32 s30, s30, 4096
    s_add_u32 m0, m0, 4096
    s_sub_u32 s31, s31, 1
    s_cmp_lg_u32 s31, 0
    s_cbranch_scc1 L28_dma
    s_mov_b32 exec_hi, 0
    buffer_load_dword v16, v4, s[4:7], s39 offen sc1
    s_mov_b64 exec, -1
    s_waitcnt vmcnt(0)
L26_val:
    ds_read_b128 v[44:47], v248 offset:0
    ds_read_b128 v[48:51], v248 offset:4096
    ds_read_b128 v[52:55], v248 offset:8192
    ds_read_b128 v[56:59], v248 offset:12288
    ds_read_b128 v[60:63], v248 offset:16384
    ds_read_b128 v[64:67], v248 offset:20480
    ds_read_b128 v[68:71], v248 offset:24576
    ds_read_b128 v[72:75], v248 offset:28672
    v_sub_u32 v10, 0, v16
    s_lshl_b32 s24, s20, 5
    s_waitcnt lgkmcnt(7)
    v_add3_u32 v10, v10, v44, v45
    v_add3_u32 v10, v10, v46, v47
    s_waitcnt lgkmcnt(6)
    v_add3_u32 v10, v10, v48, v49
    v_add3_u32 v10, v10, v50, v51
    s_waitcnt lgkmcnt(5)
    v_add3_u32 v10, v10, v52, v53
    v_add3_u32 v10, v10, v54, v55
    s_waitcnt lgkmcnt(4)
    v_add3_u32 v10, v10, v56, v57
    v_add3_u32 v10, v10, v58, v59
    s_waitcnt lgkmcnt(3)
    v_add3_u32 v10, v10, v60, v61
    v_add3_u32 v10, v10, v62, v63
    s_waitcnt lgkmcnt(2)
    v_add3_u32 v10, v10, v64, v65
    v_add3_u32 v10, v10, v66, v67
    s_waitcnt lgkmcnt(1)
    v_add3_u32 v10, v10, v68, v69
    v_add3_u32 v10, v10, v70, v71
    s_waitcnt lgkmcnt(0)
    v_add3_u32 v10, v10, v72, v73
    v_add3_u32 v10, v10, v74, v75
    s_nop 1
    v_add_u32_dpp v10, v10, v10 row_ror:8 row_mask:0xf bank_mask:0xf
    s_nop 1
    v_add_u32_dpp v10, v10, v10 row_ror:4 row_mask:0xf bank_mask:0xf
    s_nop 1
    v_add_u32_dpp v10, v10, v10 row_ror:2 row_mask:0xf bank_mask:0xf
    s_nop 1
    v_add_u32_dpp v10, v10, v10 row_ror:1 row_mask:0xf bank_mask:0xf
    v_mov_b32 v13, v10
    s_nop 1
    v_permlane16_swap_b32 v10, v13
    s_nop 0
    v_add_u32 v10, v10, v13
    v_mov_b32 v13, v10
    s_nop 1
    v_permlane32_swap_b32 v10, v13
    s_nop 0
    v_add_u32 v10, v10, v13
    v_add_u32 v10, s24, v10
    v_cmp_ne_u32 vcc, 0, v10
    s_cbranch_vccz L29_ok
    s_add_u32 s23, s23, 1
    s_cmp_lt_u32 s23, 32768
    s_cbranch_scc1 L27_qa
L29_ok:
    s_barrier
    ds_read_b128 v[44:47], v26 offset:0
    ds_read_b128 v[48:51], v27 offset:0
    ds_read_b128 v[52:55], v28 offset:0
    ds_read_b128 v[56:59], v29 offset:0
    ds_read_b128 v[60:63], v30 offset:0
    s_sub_u32 s24, s2, 128
    s_lshl_b32 s24, s24, 7
    s_add_u32 s24, s24, 212992
    s_cmp_eq_u32 s3, 0
    s_cselect_b32 s24, s24, 10485760
    v_mov_b32 v17, s20
    s_mov_b32 exec_hi, 0
    buffer_store_dword v17, v251, s[4:7], s24 offen
    s_mov_b64 exec, -1
    s_lshr_b32 s24, s35, 3
    s_lshl_b32 s24, s24, 2
    s_add_u32 s24, s24, s3
    s_lshl_b32 s24, s24, 13
    s_lshl_b32 s25, s34, 6
    s_add_u32 s24, s24, s25
    s_add_u32 s24, s24, 262144
    buffer_load_dword v228, v232, s[4:7], s24 offen sc1
    ds_read_b128 v[64:67], v31 offset:0
    ds_read_b128 a[64:67], v34 offset:32768
    s_waitcnt lgkmcnt(6)
    v_mfma_f32_32x32x16_bf16 v[76:91], a[0:3], v[44:47], 0
    s_lshl_b32 s24, s38, 16
    s_lshl_b32 s25, s34, 10
    s_add_u32 s24, s24, s25
    buffer_load_dword v231, v250, s[12:15], s24 offen
    ds_read_b128 v[68:71], v32 offset:0
    ds_read_b128 a[68:71], v35 offset:32768
    s_waitcnt lgkmcnt(7)
    v_mfma_f32_32x32x16_bf16 v[76:91], a[4:7], v[48:51], v[76:91]
    ds_read_b128 v[72:75], v33 offset:0
    ds_read_b128 a[72:75], v36 offset:32768
    s_waitcnt lgkmcnt(8)
    v_mfma_f32_32x32x16_bf16 v[76:91], a[8:11], v[52:55], v[76:91]
    ds_read_b128 v[44:47], v26 offset:16384
    ds_read_b128 a[76:79], v37 offset:32768
    s_waitcnt lgkmcnt(9)
    v_mfma_f32_32x32x16_bf16 v[76:91], a[12:15], v[56:59], v[76:91]
    ds_read_b128 v[48:51], v27 offset:16384
    ds_read_b128 a[80:83], v38 offset:32768
    s_waitcnt lgkmcnt(10)
    v_mfma_f32_32x32x16_bf16 v[76:91], a[16:19], v[60:63], v[76:91]
    ds_read_b128 v[52:55], v28 offset:16384
    ds_read_b128 a[84:87], v39 offset:32768
    s_waitcnt lgkmcnt(11)
    v_mfma_f32_32x32x16_bf16 v[76:91], a[20:23], v[64:67], v[76:91]
    ds_read_b128 v[56:59], v29 offset:16384
    ds_read_b128 a[88:91], v40 offset:32768
    s_waitcnt lgkmcnt(11)
    v_mfma_f32_32x32x16_bf16 v[76:91], a[24:27], v[68:71], v[76:91]
    ds_read_b128 v[60:63], v30 offset:16384
    ds_read_b128 a[92:95], v41 offset:32768
    s_waitcnt lgkmcnt(11)
    v_mfma_f32_32x32x16_bf16 v[76:91], a[28:31], v[72:75], v[76:91]
    ds_read_b128 v[64:67], v31 offset:16384
    s_waitcnt lgkmcnt(10)
    v_mfma_f32_32x32x16_bf16 v[76:91], a[32:35], v[44:47], v[76:91]
    ds_read_b128 v[68:71], v32 offset:16384
    s_waitcnt lgkmcnt(9)
    v_mfma_f32_32x32x16_bf16 v[76:91], a[36:39], v[48:51], v[76:91]
    ds_read_b128 v[72:75], v33 offset:16384
    s_waitcnt lgkmcnt(8)
    v_mfma_f32_32x32x16_bf16 v[76:91], a[40:43], v[52:55], v[76:91]
    ds_read_b128 v[44:47], v26 offset:24576
    s_waitcnt lgkmcnt(7)
    v_mfma_f32_32x32x16_bf16 v[76:91], a[44:47], v[56:59], v[76:91]
    ds_read_b128 v[48:51], v27 offset:24576
    s_waitcnt lgkmcnt(6)
    v_mfma_f32_32x32x16_bf16 v[76:91], a[48:51], v[60:63], v[76:91]
    ds_read_b128 v[52:55], v28 offset:24576
    s_waitcnt lgkmcnt(5)
    v_mfma_f32_32x32x16_bf16 v[76:91], a[52:55], v[64:67], v[76:91]
    ds_read_b128 v[56:59], v29 offset:24576
    s_waitcnt lgkmcnt(5)
    v_mfma_f32_32x32x16_bf16 v[76:91], a[56:59], v[68:71], v[76:91]
    ds_read_b128 v[60:63], v30 offset:24576
    s_waitcnt lgkmcnt(5)
    v_mfma_f32_32x32x16_bf16 v[76:91], a[60:63], v[72:75], v[76:91]
    ds_read_b128 v[64:67], v31 offset:24576
    s_waitcnt lgkmcnt(5)
    v_mfma_f32_32x32x16_bf16 v[76:91], a[64:67], v[44:47], v[76:91]
    ds_read_b128 v[68:71], v32 offset:24576
    s_waitcnt lgkmcnt(5)
    v_mfma_f32_32x32x16_bf16 v[76:91], a[68:71], v[48:51], v[76:91]
    ds_read_b128 v[72:75], v33 offset:24576
    ds_read_b128 v[132:135], v26 offset:8192
    s_waitcnt lgkmcnt(6)
    v_mfma_f32_32x32x16_bf16 v[76:91], a[72:75], v[52:55], v[76:91]
    ds_read_b128 v[136:139], v27 offset:8192
    ds_read_b128 v[140:143], v28 offset:8192
    s_waitcnt lgkmcnt(7)
    v_mfma_f32_32x32x16_bf16 v[76:91], a[76:79], v[56:59], v[76:91]
    ds_read_b128 v[144:147], v29 offset:8192
    ds_read_b128 v[148:151], v30 offset:8192
    s_waitcnt lgkmcnt(8)
    v_mfma_f32_32x32x16_bf16 v[76:91], a[80:83], v[60:63], v[76:91]
    ds_read_b128 v[152:155], v31 offset:8192
    ds_read_b128 v[156:159], v32 offset:8192
    s_waitcnt lgkmcnt(9)
    v_mfma_f32_32x32x16_bf16 v[76:91], a[84:87], v[64:67], v[76:91]
    ds_read_b128 v[160:163], v33 offset:8192
    s_waitcnt lgkmcnt(9)
    v_mfma_f32_32x32x16_bf16 v[76:91], a[88:91], v[68:71], v[76:91]
    s_waitcnt lgkmcnt(8)
    v_mfma_f32_32x32x16_bf16 v[76:91], a[92:95], v[72:75], v[76:91]
    s_waitcnt vmcnt(3)
    ds_read_b128 a[96:99], v18 offset:32768
    ds_read_b128 a[100:103], v19 offset:32768
    ds_read_b128 a[104:107], v20 offset:32768
    ds_read_b128 a[108:111], v21 offset:32768
    s_barrier
    ds_read_b128 a[112:115], v22 offset:32768
    ds_read_b64_tr_b16 a[128:129], v92 offset:0
    ds_read_b64_tr_b16 a[130:131], v93 offset:2048
    s_waitcnt lgkmcnt(6)
    v_mfma_f32_32x32x16_bf16 v[76:91], a[96:99], v[132:135], v[76:91]
    ds_read_b128 a[116:119], v23 offset:32768
    ds_read_b64_tr_b16 a[132:133], v94 offset:0
    ds_read_b64_tr_b16 a[134:135], v95 offset:2048
    s_waitcnt lgkmcnt(8)
    v_mfma_f32_32x32x16_bf16 v[76:91], a[100:103], v[136:139], v[76:91]
    ds_read_b128 a[120:123], v24 offset:32768
    ds_read_b64_tr_b16 a[136:137], v96 offset:0
    ds_read_b64_tr_b16 a[138:139], v97 offset:2048
    s_waitcnt lgkmcnt(10)
    v_mfma_f32_32x32x16_bf16 v[76:91], a[104:107], v[140:143], v[76:91]
    ds_read_b128 a[124:127], v25 offset:32768
    ds_read_b64_tr_b16 a[140:141], v98 offset:0
    ds_read_b64_tr_b16 a[142:143], v99 offset:2048
    s_waitcnt lgkmcnt(12)
    v_mfma_f32_32x32x16_bf16 v[76:91], a[108:111], v[144:147], v[76:91]
    ds_read_b64_tr_b16 a[144:145], v92 offset:4096
    ds_read_b64_tr_b16 a[146:147], v93 offset:6144
    ds_read_b64_tr_b16 a[148:149], v94 offset:4096
    ds_read_b64_tr_b16 a[150:151], v95 offset:6144
    s_waitcnt lgkmcnt(14)
    v_mfma_f32_32x32x16_bf16 v[76:91], a[112:115], v[148:151], v[76:91]
    ds_read_b64_tr_b16 a[152:153], v96 offset:4096
    ds_read_b64_tr_b16 a[154:155], v97 offset:6144
    ds_read_b64_tr_b16 a[156:157], v98 offset:4096
    ds_read_b64_tr_b16 a[158:159], v99 offset:6144
    s_waitcnt lgkmcnt(14)
    v_mfma_f32_32x32x16_bf16 v[76:91], a[116:119], v[152:155], v[76:91]
    ds_read_b64_tr_b16 a[160:161], v100 offset:0
    ds_read_b64_tr_b16 a[162:163], v101 offset:2048
    ds_read_b64_tr_b16 a[164:165], v102 offset:0
    ds_read_b64_tr_b16 a[166:167], v103 offset:2048
    s_waitcnt lgkmcnt(14)
    v_mfma_f32_32x32x16_bf16 v[76:91], a[120:123], v[156:159], v[76:91]
    ds_read_b64_tr_b16 a[168:169], v100 offset:4096
    ds_read_b64_tr_b16 a[170:171], v101 offset:6144
    ds_read_b64_tr_b16 a[172:173], v102 offset:4096
    ds_read_b64_tr_b16 a[174:175], v103 offset:6144
    v_mfma_f32_32x32x16_bf16 v[76:91], a[124:127], v[160:163], v[76:91]
    ds_read_b64_tr_b16 a[176:177], v108 offset:0
    ds_read_b64_tr_b16 a[178:179], v109 offset:2048
    ds_read_b64_tr_b16 a[180:181], v110 offset:0
    ds_read_b64_tr_b16 a[182:183], v111 offset:2048
    s_lshr_b32 s31, s35, 3
    s_lshl_b32 s31, s31, 2
    s_add_u32 s31, s31, s3
    s_and_b32 s26, s35, 7
    s_lshl_b32 s30, s31, 13
    s_lshl_b32 s24, s34, 6
    s_add_u32 s30, s30, s24
    s_add_u32 s30, s30, 262144
    v_max3_f32 v10, v76, v77, v78
    v_max3_f32 v11, v79, v80, v81
    v_max3_f32 v10, v10, v82, v83
    v_max3_f32 v11, v11, v84, v85
    v_max3_f32 v10, v10, v86, v87
    v_max3_f32 v11, v11, v88, v89
    v_max3_f32 v10, v10, v90, v91
    v_max_f32 v10, v10, v11
    v_mov_b32 v11, v10
    s_nop 1
    v_permlane32_swap_b32 v10, v11
    s_nop 0
    v_max_f32 v10, v10, v11
    ds_write_b32 v241, v10
    ds_read_b64_tr_b16 a[184:185], v108 offset:4096
    ds_read_b64_tr_b16 a[186:187], v109 offset:6144
    ds_read_b64_tr_b16 a[188:189], v110 offset:4096
    ds_read_b64_tr_b16 a[190:191], v111 offset:6144
    ds_read_b64_tr_b16 a[192:193], v116 offset:0
    ds_read_b64_tr_b16 a[194:195], v117 offset:2048
    s_waitcnt lgkmcnt(6)
    s_barrier
    ds_read2_b32 v[26:27], v240 offset0:0 offset1:32
    ds_read2_b32 v[28:29], v240 offset0:64 offset1:96
    ds_read_b64_tr_b16 a[196:197], v118 offset:0
    ds_read_b64_tr_b16 a[198:199], v119 offset:2048
    ds_read_b64_tr_b16 a[200:201], v116 offset:4096
    ds_read_b64_tr_b16 a[202:203], v117 offset:6144
    ds_read_b64_tr_b16 a[204:205], v118 offset:4096
    ds_read_b64_tr_b16 a[206:207], v119 offset:6144
    s_waitcnt lgkmcnt(6)
    v_max3_f32 v10, v26, v27, v28
    v_max_f32 v10, v10, v29
    v_pk_add_f32 v[76:77], v[76:77], v[10:11] op_sel_hi:[1,0] neg_lo:[0,1] neg_hi:[0,1]
    v_pk_add_f32 v[78:79], v[78:79], v[10:11] op_sel_hi:[1,0] neg_lo:[0,1] neg_hi:[0,1]
    v_pk_add_f32 v[80:81], v[80:81], v[10:11] op_sel_hi:[1,0] neg_lo:[0,1] neg_hi:[0,1]
    v_pk_add_f32 v[82:83], v[82:83], v[10:11] op_sel_hi:[1,0] neg_lo:[0,1] neg_hi:[0,1]
    v_pk_add_f32 v[84:85], v[84:85], v[10:11] op_sel_hi:[1,0] neg_lo:[0,1] neg_hi:[0,1]
    v_pk_add_f32 v[86:87], v[86:87], v[10:11] op_sel_hi:[1,0] neg_lo:[0,1] neg_hi:[0,1]
    v_pk_add_f32 v[88:89], v[88:89], v[10:11] op_sel_hi:[1,0] neg_lo:[0,1] neg_hi:[0,1]
    v_pk_add_f32 v[90:91], v[90:91], v[10:11] op_sel_hi:[1,0] neg_lo:[0,1] neg_hi:[0,1]
    v_exp_f32 v76, v76
    v_exp_f32 v77, v77
    v_exp_f32 v78, v78
    v_exp_f32 v79, v79
    v_exp_f32 v80, v80
    v_exp_f32 v81, v81
    v_exp_f32 v82, v82
    v_exp_f32 v83, v83
    v_cvt_pk_bf16_f32 v44, v76, v77
    v_cvt_pk_bf16_f32 v45, v78, v79
    v_cvt_pk_bf16_f32 v46, v80, v81
    v_cvt_pk_bf16_f32 v47, v82, v83
    ds_write_b128 v242, v[44:47] offset:17408
    v_exp_f32 v84, v84
    v_mfma_f32_32x32x16_bf16 v[132:147], v[44:47], a[128:131], 0
    v_exp_f32 v85, v85
    v_exp_f32 v86, v86
    v_exp_f32 v87, v87
    v_mfma_f32_32x32x16_bf16 v[148:163], v[44:47], a[132:135], 0
    v_exp_f32 v88, v88
    v_exp_f32 v89, v89
    v_exp_f32 v90, v90
    v_mfma_f32_32x32x16_bf16 v[164:179], v[44:47], a[136:139], 0
    v_exp_f32 v91, v91
    v_cvt_pk_bf16_f32 v48, v84, v85
    v_cvt_pk_bf16_f32 v49, v86, v87
    v_cvt_pk_bf16_f32 v50, v88, v89
    v_cvt_pk_bf16_f32 v51, v90, v91
    ds_write_b128 v242, v[48:51] offset:18432
    v_mfma_f32_32x32x16_bf16 v[180:195], v[44:47], a[140:143], 0
    s_waitcnt lgkmcnt(0)
    s_barrier
    ds_read_b128 v[52:55], v243 offset:17408
    ds_read_b128 v[56:59], v243 offset:18432
    v_mfma_f32_32x32x16_bf16 v[132:147], v[48:51], a[144:147], v[132:147]
    v_add_f32 v76, v76, v84
    v_add_f32 v77, v77, v85
    v_add_f32 v78, v78, v86
    v_add_f32 v79, v79, v87
    ds_read_b128 v[60:63], v244 offset:17408
    ds_read_b128 v[64:67], v244 offset:18432
    v_mfma_f32_32x32x16_bf16 v[148:163], v[48:51], a[148:151], v[148:163]
    v_add_f32 v80, v80, v88
    v_add_f32 v81, v81, v89
    v_add_f32 v82, v82, v90
    v_add_f32 v83, v83, v91
    ds_read_b128 v[68:71], v245 offset:17408
    ds_read_b128 v[72:75], v245 offset:18432
    v_mfma_f32_32x32x16_bf16 v[164:179], v[48:51], a[152:155], v[164:179]
    v_add_f32 v76, v76, v80
    v_add_f32 v77, v77, v81
    v_add_f32 v78, v78, v82
    v_add_f32 v79, v79, v83
    ds_read_b64_tr_b16 a[208:209], v104 offset:0
    ds_read_b64_tr_b16 a[210:211], v105 offset:2048
    v_mfma_f32_32x32x16_bf16 v[180:195], v[48:51], a[156:159], v[180:195]
    v_add_f32 v76, v76, v78
    v_add_f32 v77, v77, v79
    v_add_f32 v12, v76, v77
    v_mov_b32 v13, v12
    ds_read_b64_tr_b16 a[212:213], v106 offset:0
    ds_read_b64_tr_b16 a[214:215], v107 offset:2048
    s_waitcnt lgkmcnt(9)
    v_mfma_f32_32x32x16_bf16 v[132:147], v[52:55], a[160:163], v[132:147]
    v_permlane32_swap_b32 v12, v13
    v_mov_b32 v76, v10
    v_add_f32 v12, v12, v13
    ds_write_b32 v241, v12 offset:512
    ds_read_b64_tr_b16 a[216:217], v104 offset:4096
    ds_read_b64_tr_b16 a[218:219], v105 offset:6144
    v_mfma_f32_32x32x16_bf16 v[148:163], v[52:55], a[164:167], v[148:163]
    ds_read_b64_tr_b16 a[220:221], v106 offset:4096
    ds_read_b64_tr_b16 a[222:223], v107 offset:6144
    s_waitcnt lgkmcnt(13)
    v_mfma_f32_32x32x16_bf16 v[132:147], v[56:59], a[168:171], v[132:147]
    ds_read_b64_tr_b16 a[224:225], v112 offset:0
    ds_read_b64_tr_b16 a[226:227], v113 offset:2048
    v_mfma_f32_32x32x16_bf16 v[148:163], v[56:59], a[172:175], v[148:163]
    s_waitcnt lgkmcnt(6)
    s_barrier
    ds_read2_b32 v[26:27], v240 offset0:128 offset1:160
    ds_read2_b32 v[28:29], v240 offset0:192 offset1:224
    ds_read_b64_tr_b16 a[228:229], v114 offset:0
    ds_read_b64_tr_b16 a[230:231], v115 offset:2048
    v_mfma_f32_32x32x16_bf16 v[132:147], v[60:63], a[176:179], v[132:147]
    ds_read_b64_tr_b16 a[232:233], v112 offset:4096
    ds_read_b64_tr_b16 a[234:235], v113 offset:6144
    v_mfma_f32_32x32x16_bf16 v[148:163], v[60:63], a[180:183], v[148:163]
    s_waitcnt lgkmcnt(4)
    v_add_f32 v77, v26, v27
    v_add_f32 v79, v28, v29
    v_mov_b32 v78, s20
    v_add_f32 v77, v77, v79
    ds_read_b64_tr_b16 a[236:237], v114 offset:4096
    ds_read_b64_tr_b16 a[238:239], v115 offset:6144
    v_mfma_f32_32x32x16_bf16 v[132:147], v[64:67], a[184:187], v[132:147]
    s_mov_b32 exec_hi, 0
    buffer_store_dwordx4 v[76:79], v3, s[4:7], s29 offen sc1
    s_mov_b64 exec, -1
    ds_read_b64_tr_b16 a[240:241], v120 offset:0
    ds_read_b64_tr_b16 a[242:243], v121 offset:2048
    v_mfma_f32_32x32x16_bf16 v[148:163], v[64:67], a[188:191], v[148:163]
    s_lshl_b32 s91, s31, 19
    s_lshl_b32 s24, s26, 12
    s_add_u32 s91, s91, s24
    s_lshl_b32 s24, s34, 9
    ds_read_b64_tr_b16 a[244:245], v122 offset:0
    ds_read_b64_tr_b16 a[246:247], v123 offset:2048
    v_mfma_f32_32x32x16_bf16 v[132:147], v[68:71], a[192:195], v[132:147]
    s_add_u32 s91, s91, s24
    s_add_u32 s91, s91, 2097152
    s_lshl_b32 s92, s34, 2
    s_add_u32 s92, s92, s3
    ds_read_b64_tr_b16 a[248:249], v120 offset:4096
    ds_read_b64_tr_b16 a[250:251], v121 offset:6144
    v_mfma_f32_32x32x16_bf16 v[148:163], v[68:71], a[196:199], v[148:163]
    s_lshl_b32 s92, s92, 12
    s_lshl_b32 s25, s35, 8
    s_add_u32 s92, s92, s25
    s_add_u32 s92, s92, 524288
    ds_read_b64_tr_b16 a[252:253], v122 offset:4096
    ds_read_b64_tr_b16 a[254:255], v123 offset:6144
    v_mfma_f32_32x32x16_bf16 v[132:147], v[72:75], a[200:203], v[132:147]
    s_lshl_b32 s90, s31, 14
    s_lshr_b32 s24, s26, 1
    s_lshl_b32 s24, s24, 8
    s_add_u32 s90, s90, s24
    v_mfma_f32_32x32x16_bf16 v[148:163], v[72:75], a[204:207], v[148:163]
    s_and_b32 s24, s26, 1
    s_lshl_b32 s24, s24, 4
    s_add_u32 s90, s90, s24
    s_brev_b32 s24, s34
    v_mfma_f32_32x32x16_bf16 v[164:179], v[52:55], a[208:211], v[164:179]
    s_lshr_b32 s24, s24, 24
    s_add_u32 s90, s90, s24
    s_add_u32 s90, s90, 393216
    v_mfma_f32_32x32x16_bf16 v[180:195], v[52:55], a[212:215], v[180:195]
    v_mfma_f32_32x32x16_bf16 v[164:179], v[56:59], a[216:219], v[164:179]
    v_mfma_f32_32x32x16_bf16 v[180:195], v[56:59], a[220:223], v[180:195]
    v_cvt_pk_bf16_f32 v196, v132, v148
    v_cvt_pk_bf16_f32 v197, v133, v149
    v_cvt_pk_bf16_f32 v198, v134, v150
    v_cvt_pk_bf16_f32 v199, v135, v151
    buffer_store_dwordx4 v[196:199], v3, s[4:7], s28 offen offset:0 sc1
    v_mfma_f32_32x32x16_bf16 v[164:179], v[60:63], a[224:227], v[164:179]
    v_add3_u32 v18, v196, v197, v198
    v_add_u32 v18, v18, v199
    s_waitcnt lgkmcnt(12)
    v_mfma_f32_32x32x16_bf16 v[180:195], v[60:63], a[228:231], v[180:195]
    v_cvt_pk_bf16_f32 v200, v136, v152
    v_cvt_pk_bf16_f32 v201, v137, v153
    v_cvt_pk_bf16_f32 v202, v138, v154
    v_cvt_pk_bf16_f32 v203, v139, v155
    buffer_store_dwordx4 v[200:203], v3, s[4:7], s28 offen offset:1024 sc1
    s_waitcnt lgkmcnt(10)
    v_mfma_f32_32x32x16_bf16 v[164:179], v[64:67], a[232:235], v[164:179]
    v_add3_u32 v19, v200, v201, v202
    v_add_u32 v19, v19, v203
    s_waitcnt lgkmcnt(8)
    v_mfma_f32_32x32x16_bf16 v[180:195], v[64:67], a[236:239], v[180:195]
    v_cvt_pk_bf16_f32 v204, v140, v156
    v_cvt_pk_bf16_f32 v205, v141, v157
    v_cvt_pk_bf16_f32 v206, v142, v158
    v_cvt_pk_bf16_f32 v207, v143, v159
    buffer_store_dwordx4 v[204:207], v3, s[4:7], s28 offen offset:2048 sc1
    s_waitcnt lgkmcnt(6)
    v_mfma_f32_32x32x16_bf16 v[164:179], v[68:71], a[240:243], v[164:179]
    v_add3_u32 v20, v204, v205, v206
    v_add_u32 v20, v20, v207
    s_waitcnt lgkmcnt(4)
    v_mfma_f32_32x32x16_bf16 v[180:195], v[68:71], a[244:247], v[180:195]
    v_cvt_pk_bf16_f32 v208, v144, v160
    v_cvt_pk_bf16_f32 v209, v145, v161
    v_cvt_pk_bf16_f32 v210, v146, v162
    v_cvt_pk_bf16_f32 v211, v147, v163
    buffer_store_dwordx4 v[208:211], v3, s[4:7], s28 offen offset:3072 sc1
    s_waitcnt lgkmcnt(2)
    v_mfma_f32_32x32x16_bf16 v[164:179], v[72:75], a[248:251], v[164:179]
    v_add3_u32 v21, v208, v209, v210
    v_add_u32 v21, v21, v211
    s_waitcnt lgkmcnt(0)
    v_mfma_f32_32x32x16_bf16 v[180:195], v[72:75], a[252:255], v[180:195]
    s_nop 0
    v_permlane16_swap_b32 v18, v19
    v_permlane16_swap_b32 v20, v21
    v_add_u32 v18, v18, v19
    v_add_u32 v20, v20, v21
    s_nop 0
    v_add_u32_dpp v22, v18, v18 row_ror:8 row_mask:0xf bank_mask:0x3
    v_add_u32_dpp v22, v20, v20 row_ror:8 row_mask:0xf bank_mask:0xc
    s_nop 1
    v_add_u32_dpp v23, v22, v22 row_half_mirror row_mask:0xf bank_mask:0x5
    s_nop 0
    v_cvt_pk_bf16_f32 v212, v164, v180
    v_cvt_pk_bf16_f32 v213, v165, v181
    v_cvt_pk_bf16_f32 v214, v166, v182
    v_cvt_pk_bf16_f32 v215, v167, v183
    buffer_store_dwordx4 v[212:215], v235, s[4:7], s28 offen offset:0 sc1
    v_cvt_pk_bf16_f32 v216, v168, v184
    v_cvt_pk_bf16_f32 v217, v169, v185
    v_cvt_pk_bf16_f32 v218, v170, v186
    v_cvt_pk_bf16_f32 v219, v171, v187
    buffer_store_dwordx4 v[216:219], v235, s[4:7], s28 offen offset:1024 sc1
    v_cvt_pk_bf16_f32 v220, v172, v188
    v_cvt_pk_bf16_f32 v221, v173, v189
    v_cvt_pk_bf16_f32 v222, v174, v190
    v_cvt_pk_bf16_f32 v223, v175, v191
    buffer_store_dwordx4 v[220:223], v235, s[4:7], s28 offen offset:2048 sc1
    v_cvt_pk_bf16_f32 v224, v176, v192
    v_cvt_pk_bf16_f32 v225, v177, v193
    v_cvt_pk_bf16_f32 v226, v178, v194
    v_cvt_pk_bf16_f32 v227, v179, v195
    buffer_store_dwordx4 v[224:227], v235, s[4:7], s28 offen offset:3072 sc1
    v_add3_u32 v18, v212, v213, v214
    v_add_u32 v18, v18, v215
    v_add3_u32 v19, v216, v217, v218
    v_add_u32 v19, v19, v219
    v_add3_u32 v20, v220, v221, v222
    v_add_u32 v20, v20, v223
    v_add3_u32 v21, v224, v225, v226
    v_add_u32 v21, v21, v227
    s_nop 1
    v_permlane16_swap_b32 v18, v19
    v_permlane16_swap_b32 v20, v21
    v_add_u32 v18, v18, v19
    v_add_u32 v20, v20, v21
    s_nop 0
    v_add_u32_dpp v22, v18, v18 row_ror:8 row_mask:0xf bank_mask:0x3
    v_add_u32_dpp v22, v20, v20 row_ror:8 row_mask:0xf bank_mask:0xc
    s_nop 1
    v_add_u32_dpp v23, v22, v22 row_half_mirror row_mask:0xf bank_mask:0xa
    s_nop 1
    v_add_u32_dpp v23, v23, v23 quad_perm:[2,3,0,1] row_mask:0xf bank_mask:0xf
    s_nop 1
    v_add_u32_dpp v23, v23, v23 quad_perm:[1,0,3,2] row_mask:0xf bank_mask:0xf
    v_add_u32 v23, s20, v23
    buffer_store_dword v23, v251, s[4:7], s32 offen sc1
    s_mov_b32 s23, 0
L30_st:
    buffer_load_dwordx4 v[88:91], v232, s[4:7], s30 offen sc1
    s_waitcnt vmcnt(0)
    v_cmp_ne_u32 vcc, s20, v90
    s_cbranch_vccz L31_ok
    s_add_u32 s23, s23, 1
    s_cmp_lt_u32 s23, 32768
    s_cbranch_scc1 L30_st
L31_ok:
    v_mov_b32 v16, 0
    s_mov_b32 s39, s91
    s_mov_b64 exec, 0xffff
    buffer_load_dword v16, v229, s[4:7], s90 offen sc1
    s_mov_b64 exec, -1
    buffer_load_dwordx4 v[92:95], v233, s[4:7], s39 offen sc1
    s_add_u32 s39, s39, 0x10000
    buffer_load_dwordx4 v[96:99], v233, s[4:7], s39 offen sc1
    s_add_u32 s39, s39, 0x10000
    buffer_load_dwordx4 v[100:103], v233, s[4:7], s39 offen sc1
    s_add_u32 s39, s39, 0x10000
    buffer_load_dwordx4 v[104:107], v233, s[4:7], s39 offen sc1
    s_add_u32 s39, s39, 0x10000
    buffer_load_dwordx4 v[108:111], v233, s[4:7], s39 offen sc1
    s_add_u32 s39, s39, 0x10000
    buffer_load_dwordx4 v[112:115], v233, s[4:7], s39 offen sc1
    s_add_u32 s39, s39, 0x10000
    buffer_load_dwordx4 v[116:119], v233, s[4:7], s39 offen sc1
    s_add_u32 s39, s39, 0x10000
    buffer_load_dwordx4 v[120:123], v233, s[4:7], s39 offen sc1
    v_max_f32_dpp v10, v88, v88 row_ror:4 row_mask:0xf bank_mask:0xf
    s_nop 1
    v_max_f32_dpp v10, v10, v10 row_ror:8 row_mask:0xf bank_mask:0xf
    v_mov_b32 v11, v10
    s_nop 1
    v_permlane16_swap_b32 v10, v11
    s_nop 0
    v_max_f32 v10, v10, v11
    v_mov_b32 v11, v10
    s_nop 1
    v_permlane32_swap_b32 v10, v11
    s_nop 0
    v_max_f32 v10, v10, v11
    v_sub_f32 v14, v88, v10
    v_exp_f32 v14, v14
    s_nop 0
    v_cvt_pk_bf16_f32 v14, v14, v14
    v_and_b32 v12, 0xffff0000, v14
    v_mul_f32 v12, v12, v89
    ds_bpermute_b32 v124, v234, v14 offset:0
    ds_bpermute_b32 v125, v234, v14 offset:32
    ds_bpermute_b32 v126, v234, v14 offset:64
    ds_bpermute_b32 v127, v234, v14 offset:96
    ds_bpermute_b32 v128, v234, v14 offset:128
    ds_bpermute_b32 v129, v234, v14 offset:160
    ds_bpermute_b32 v130, v234, v14 offset:192
    ds_bpermute_b32 v131, v234, v14 offset:224
    s_nop 1
    v_add_f32_dpp v12, v12, v12 row_ror:4 row_mask:0xf bank_mask:0xf
    s_nop 1
    v_add_f32_dpp v12, v12, v12 row_ror:8 row_mask:0xf bank_mask:0xf
    v_mov_b32 v13, v12
    s_nop 1
    v_permlane16_swap_b32 v12, v13
    s_nop 0
    v_add_f32 v12, v12, v13
    v_mov_b32 v13, v12
    s_nop 1
    v_permlane32_swap_b32 v12, v13
    s_nop 0
    v_add_f32 v12, v12, v13
    v_mov_b32 v11, v12
    s_lshl_b32 s25, s20, 4
    ds_write_b64 v42, v[10:11]
    ds_bpermute_b32 v8, v247, v10
    s_waitcnt lgkmcnt(2)
    v_and_b32 v132, v236, v124
    v_and_b32 v133, v237, v124
    v_and_b32 v134, v238, v124
    v_and_b32 v135, v239, v124
    v_and_b32 v136, v236, v125
    v_and_b32 v137, v237, v125
    v_and_b32 v138, v238, v125
    v_and_b32 v139, v239, v125
    v_and_b32 v140, v236, v126
    v_and_b32 v141, v237, v126
    v_and_b32 v142, v238, v126
    v_and_b32 v143, v239, v126
    v_and_b32 v144, v236, v127
    v_and_b32 v145, v237, v127
    v_and_b32 v146, v238, v127
    v_and_b32 v147, v239, v127
    s_waitcnt lgkmcnt(0)
    s_barrier
    ds_read2_b64 v[80:83], v43 offset0:0 offset1:4
    ds_read2_b64 v[84:87], v43 offset0:8 offset1:12
    v_and_b32 v148, v236, v128
    v_and_b32 v149, v237, v128
    v_and_b32 v150, v238, v128
    v_and_b32 v151, v239, v128
    v_and_b32 v152, v236, v129
    v_and_b32 v153, v237, v129
    v_and_b32 v154, v238, v129
    v_and_b32 v155, v239, v129
    v_and_b32 v156, v236, v130
    v_and_b32 v157, v237, v130
    v_and_b32 v158, v238, v130
    v_and_b32 v159, v239, v130
    v_and_b32 v160, v236, v131
    v_and_b32 v161, v237, v131
    v_and_b32 v162, v238, v131
    v_and_b32 v163, v239, v131
    s_waitcnt lgkmcnt(0)
    v_max3_f32 v9, v80, v82, v84
    v_max_f32 v9, v9, v86
    v_sub_f32 v80, v80, v9
    v_sub_f32 v82, v82, v9
    v_sub_f32 v84, v84, v9
    v_sub_f32 v86, v86, v9
    v_sub_f32 v8, v8, v9
    v_exp_f32 v80, v80
    v_exp_f32 v82, v82
    v_exp_f32 v84, v84
    v_exp_f32 v86, v86
    v_exp_f32 v8, v8
    v_mul_f32 v9, v80, v81
    v_fmac_f32 v9, v82, v83
    v_fmac_f32 v9, v84, v85
    v_fmac_f32 v9, v86, v87
    v_rcp_f32 v9, v9
    s_nop 0
    v_mul_f32 v8, v8, v9
    s_mov_b32 s23, 0
    s_branch L32_mm
L33_dat:
    s_mov_b32 s39, s91
    s_mov_b64 exec, 0xffff
    buffer_load_dword v16, v229, s[4:7], s90 offen sc1
    s_mov_b64 exec, -1
    buffer_load_dwordx4 v[92:95], v233, s[4:7], s39 offen sc1
    s_add_u32 s39, s39, 0x10000
    buffer_load_dwordx4 v[96:99], v233, s[4:7], s39 offen sc1
    s_add_u32 s39, s39, 0x10000
    buffer_load_dwordx4 v[100:103], v233, s[4:7], s39 offen sc1
    s_add_u32 s39, s39, 0x10000
    buffer_load_dwordx4 v[104:107], v233, s[4:7], s39 offen sc1
    s_add_u32 s39, s39, 0x10000
    buffer_load_dwordx4 v[108:111], v233, s[4:7], s39 offen sc1
    s_add_u32 s39, s39, 0x10000
    buffer_load_dwordx4 v[112:115], v233, s[4:7], s39 offen sc1
    s_add_u32 s39, s39, 0x10000
    buffer_load_dwordx4 v[116:119], v233, s[4:7], s39 offen sc1
    s_add_u32 s39, s39, 0x10000
    buffer_load_dwordx4 v[120:123], v233, s[4:7], s39 offen sc1
L32_mm:
    s_waitcnt vmcnt(8) lgkmcnt(0)
    v_sub_u32 v10, 0, v16
    s_waitcnt vmcnt(7)
    v_mfma_f32_16x16x32_bf16 v[164:167], v[132:135], v[92:95], 0
    v_add3_u32 v10, v10, v92, v93
    v_add3_u32 v10, v10, v94, v95
    s_waitcnt vmcnt(6)
    v_mfma_f32_16x16x32_bf16 v[164:167], v[136:139], v[96:99], v[164:167]
    v_add3_u32 v10, v10, v96, v97
    v_add3_u32 v10, v10, v98, v99
    s_waitcnt vmcnt(5)
    v_mfma_f32_16x16x32_bf16 v[164:167], v[140:143], v[100:103], v[164:167]
    v_add3_u32 v10, v10, v100, v101
    v_add3_u32 v10, v10, v102, v103
    s_waitcnt vmcnt(4)
    v_mfma_f32_16x16x32_bf16 v[164:167], v[144:147], v[104:107], v[164:167]
    v_add3_u32 v10, v10, v104, v105
    v_add3_u32 v10, v10, v106, v107
    s_waitcnt vmcnt(3)
    v_mfma_f32_16x16x32_bf16 v[164:167], v[148:151], v[108:111], v[164:167]
    v_add3_u32 v10, v10, v108, v109
    v_add3_u32 v10, v10, v110, v111
    s_waitcnt vmcnt(2)
    v_mfma_f32_16x16x32_bf16 v[164:167], v[152:155], v[112:115], v[164:167]
    v_add3_u32 v10, v10, v112, v113
    v_add3_u32 v10, v10, v114, v115
    s_waitcnt vmcnt(1)
    v_mfma_f32_16x16x32_bf16 v[164:167], v[156:159], v[116:119], v[164:167]
    v_add3_u32 v10, v10, v116, v117
    v_add3_u32 v10, v10, v118, v119
    s_waitcnt vmcnt(0)
    v_mfma_f32_16x16x32_bf16 v[164:167], v[160:163], v[120:123], v[164:167]
    v_add3_u32 v10, v10, v120, v121
    v_add3_u32 v10, v10, v122, v123
    s_nop 1
    v_add_u32_dpp v10, v10, v10 row_ror:8 row_mask:0xf bank_mask:0xf
    s_nop 1
    v_add_u32_dpp v10, v10, v10 row_ror:4 row_mask:0xf bank_mask:0xf
    v_pk_mul_f32 v[164:165], v[164:165], v[8:9] op_sel_hi:[1,0]
    v_pk_mul_f32 v[166:167], v[166:167], v[8:9] op_sel_hi:[1,0]
    v_add_u32_dpp v10, v10, v10 row_ror:2 row_mask:0xf bank_mask:0xf
    ds_write_b128 v248, v[164:167]
    s_nop 0
    v_add_u32_dpp v10, v10, v10 row_ror:1 row_mask:0xf bank_mask:0xf
    v_mov_b32 v11, v10
    s_nop 1
    v_permlane16_swap_b32 v10, v11
    s_nop 0
    v_add_u32 v10, v10, v11
    v_mov_b32 v11, v10
    s_nop 1
    v_permlane32_swap_b32 v10, v11
    s_nop 0
    v_add_u32 v10, v10, v11
    v_add_u32 v10, s25, v10
    v_cmp_ne_u32 vcc, 0, v10
    s_cbranch_vccz L34_ok
    s_add_u32 s23, s23, 1
    s_cmp_lt_u32 s23, 32768
    s_cbranch_scc1 L33_dat
L34_ok:
    s_waitcnt lgkmcnt(0)
    s_barrier
    ds_read2st64_b32 v[164:165], v246 offset0:0 offset1:4
    ds_read2st64_b32 v[166:167], v246 offset0:8 offset1:12
    s_xor_b32 s93, s92, 8388608
    s_waitcnt lgkmcnt(0)
    v_pk_add_f32 v[164:165], v[164:165], v[166:167]
    v_add_f32 v164, v164, v165
    v_bfi_b32 v164, s22, v5, v164
    buffer_store_dword v164, v251, s[4:7], s92 offen
    buffer_store_dword v164, v251, s[4:7], s93 offen sc1
    s_sub_u32 s28, s2, 128
    s_cmp_ge_u32 s28, 40
    s_cbranch_scc1 L35_Aend
    s_lshr_b32 s24, s28, 1
    s_mul_i32 s25, s24, 52
    s_lshr_b32 s25, s25, 8
    s_mul_i32 s26, s25, 5
    s_sub_u32 s24, s24, s26
    s_lshl_b32 s24, s24, 8
    s_lshl_b32 s25, s25, 5
    s_add_u32 s24, s24, s25
    s_and_b32 s25, s28, 1
    s_lshl_b32 s25, s25, 4
    s_add_u32 s24, s24, s25
    v_lshrrev_b32 v6, 5, v0
    v_lshlrev_b32 v6, 7, v6
    v_bfe_u32 v7, v0, 4, 1
    v_mul_u32_u24 v7, 1280, v7
    v_and_b32 v8, 7, v0
    v_lshlrev_b32 v8, 1, v8
    v_add3_u32 v6, v6, v7, v8
    v_add_u32 v6, s24, v6
    s_lshl_b32 s24, s28, 13
    s_lshl_b32 s25, s3, 11
    s_add_u32 s24, s24, s25
    s_add_u32 s30, s24, 1441792
    s_add_u32 s39, s24, 1114112
    v_lshlrev_b32 v10, 2, v0
    s_lshl_b32 s25, s3, 8
    v_add_u32 v11, s25, v10
    s_mov_b64 s[12:13], s[64:65]
    s_mov_b32 s14, 2560
    s_mov_b32 s15, 0x20000
    s_mov_b64 s[16:17], s[84:85]
    s_mov_b32 s18, 2560
    s_mov_b32 s19, 0x20000
    buffer_load_ushort v7, v6, s[12:15], 0 offen
    s_lshl_b32 s24, s3, 11
    s_lshl_b32 s25, s34, 13
    s_add_u32 s24, s24, s25
    s_add_u32 s24, s24, 1048576
    s_mov_b64 exec, 0xffff
    s_mov_b32 s23, 0
L36_sh:
    buffer_load_dword v14, v249, s[4:7], s24 offen sc1
    s_waitcnt vmcnt(0)
    v_xor_b32 v13, s21, v14
    v_and_b32 v13, 0x1ff, v13
    v_cmp_ne_u32 vcc, 0, v13
    s_cbranch_vccz L37_ok
    s_add_u32 s23, s23, 1
    s_cmp_lt_u32 s23, 32768
    s_cbranch_scc1 L36_sh
L37_ok:
    s_mov_b64 exec, -1
    s_mov_b32 s23, 0
L38_sp:
    buffer_load_dwordx4 v[92:95], v3, s[4:7], s30 offen sc1
    buffer_load_dwordx4 v[96:99], v3, s[4:7], s30 offen offset:1024 sc1
    buffer_load_dwordx4 v[100:103], v3, s[4:7], s39 offen sc1
    buffer_load_dwordx4 v[104:107], v3, s[4:7], s39 offen offset:1024 sc1
    s_waitcnt vmcnt(2)
    v_pk_add_f32 v[108:109], v[92:93], v[96:97]
    v_pk_add_f32 v[110:111], v[94:95], v[98:99]
    v_xor_b32 v13, s21, v92
    v_bitop3_b32 v13, v13, v93, s21 bitop3:0xf6
    v_permlane32_swap_b32 v108, v110
    v_permlane32_swap_b32 v109, v111
    v_bitop3_b32 v13, v13, v94, s21 bitop3:0xf6
    v_pk_add_f32 v[108:109], v[108:109], v[110:111]
    v_bitop3_b32 v13, v13, v95, s21 bitop3:0xf6
    v_bitop3_b32 v13, v13, v96, s21 bitop3:0xf6
    v_permlane16_swap_b32 v108, v109
    v_bitop3_b32 v13, v13, v97, s21 bitop3:0xf6
    v_add_f32 v108, v108, v109
    v_bitop3_b32 v13, v13, v98, s21 bitop3:0xf6
    v_bitop3_b32 v13, v13, v99, s21 bitop3:0xf6
    v_add_f32_dpp v108, v108, v108 row_ror:8 row_mask:0xf bank_mask:0xf
    ds_write_b32 v11, v108 offset:0
    s_waitcnt vmcnt(0)
    v_pk_add_f32 v[116:117], v[100:101], v[104:105]
    v_pk_add_f32 v[118:119], v[102:103], v[106:107]
    v_bitop3_b32 v13, v13, v100, s21 bitop3:0xf6
    v_bitop3_b32 v13, v13, v101, s21 bitop3:0xf6
    v_permlane32_swap_b32 v116, v118
    v_permlane32_swap_b32 v117, v119
    v_bitop3_b32 v13, v13, v102, s21 bitop3:0xf6
    v_pk_add_f32 v[116:117], v[116:117], v[118:119]
    v_bitop3_b32 v13, v13, v103, s21 bitop3:0xf6
    v_bitop3_b32 v13, v13, v104, s21 bitop3:0xf6
    v_permlane16_swap_b32 v116, v117
    v_bitop3_b32 v13, v13, v105, s21 bitop3:0xf6
    v_add_f32 v116, v116, v117
    v_bitop3_b32 v13, v13, v106, s21 bitop3:0xf6
    v_bitop3_b32 v13, v13, v107, s21 bitop3:0xf6
    v_add_f32_dpp v116, v116, v116 row_ror:8 row_mask:0xf bank_mask:0xf
    ds_write_b32 v11, v116 offset:1024
    v_and_b32 v13, 0x1ff, v13
    v_cmp_ne_u32 vcc, 0, v13
    s_cbranch_vccz L39_ok
    s_add_u32 s23, s23, 1
    s_cmp_lt_u32 s23, 32768
    s_cbranch_scc1 L38_sp
L39_ok:
    s_waitcnt lgkmcnt(0)
    s_barrier
    ds_read2st64_b32 v[96:97], v10 offset0:0 offset1:1
    ds_read2st64_b32 v[98:99], v10 offset0:2 offset1:3
    ds_read2st64_b32 v[92:93], v10 offset0:4 offset1:5
    ds_read2st64_b32 v[94:95], v10 offset0:6 offset1:7
    s_mov_b32 s60, 0x00ff00ff
    s_mov_b32 s61, 0x00ff00ff
    v_lshlrev_b32 v7, 16, v7
    s_waitcnt lgkmcnt(2)
    v_pk_add_f32 v[96:97], v[96:97], v[98:99]
    v_add_f32 v8, v96, v97
    v_mul_f32 v9, -1.4426950408889634, v8
    v_exp_f32 v9, v9
    s_waitcnt lgkmcnt(0)
    v_add_f32 v9, 1.0, v9
    v_rcp_f32 v9, v9
    v_pk_add_f32 v[92:93], v[92:93], v[94:95]
    v_mul_f32 v8, v8, v9
    s_cmp_lg_u32 s3, 0
    s_cbranch_scc1 L_zother
    v_add_f32 v9, v92, v93
    v_fmac_f32 v7, v8, v9
    v_cvt_pk_bf16_f32 v7, v7, v7
    s_mov_b64 exec, s[60:61]
    buffer_store_short v7, v6, s[16:19], 0 offen
    s_branch L35_Aend
L_zother:
    s_add_u32 s28, s28, s3
    s_cmp_lg_u32 s28, 1
    s_cbranch_scc1 L35_Aend
    s_mov_b32 exec_hi, 0
    v_mov_b32 v8, s20
    buffer_store_dword v8, v10, s[4:7], 0 offen sc1
L35_Aend:
    s_endpgm
L_codeend:
.section .rodata,"a"
.p2align 6
.amdhsa_kernel recurrent_scan__compressed_kv_cla__geglu_ffn__decode_kernel
  .amdhsa_next_free_vgpr 512
  .amdhsa_next_free_sgpr 96
  .amdhsa_accum_offset 256
  .amdhsa_group_segment_fixed_size 0
  .amdhsa_kernarg_size 104
  .amdhsa_user_sgpr_count 2
  .amdhsa_user_sgpr_kernarg_segment_ptr 1
  .amdhsa_system_sgpr_workgroup_id_x 1
.end_amdhsa_kernel
```
